```python
import torch

def _softmax(x, axis=-1):
    return torch.softmax(x, dim=axis)
def _gelu(x):
    return torch.nn.functional.gelu(x, approximate="tanh")
def _silu(x):
    return torch.nn.functional.silu(x)
def _sigmoid(x):
    return torch.sigmoid(x)
def _layernorm(x, axis=-1, eps=1e-5):
    m = x.mean(dim=axis, keepdim=True)
    v = x.var(dim=axis, keepdim=True, unbiased=False)
    return (x - m) / torch.sqrt(v + eps)
def _scatter_add(tgt, idx, src, axis=0):
    return tgt.clone().index_add_(axis, idx, src)
def _segment_sum(src, seg, n):
    out = torch.zeros((n,) + src.shape[1:], dtype=src.dtype)
    return out.index_add_(0, seg, src)
def _pad(x, pw):
    flat = tuple(v for pair in reversed(pw) for v in pair)
    return torch.nn.functional.pad(x, flat)

kernel_name = 'concat_heads__grouped_kv_mqa__spectral_gfnet__prompt'

def setup_inputs():

    _w = (lambda a: (lambda t: t.to(torch.bfloat16) if t.is_floating_point() else t)(torch.as_tensor(a)))
    def _A_setup():
        B, S, D, H = 1, 2048, 512, 32
        Dh = D // H
        return {
            "x": _w((lambda *s: torch.randn(*s, dtype=torch.bfloat16) * 0.05)(B, S, D)),
            "wq": _w((lambda *s: torch.randn(*s, dtype=torch.bfloat16) * 0.8)(D, H * Dh)),
            "wk": _w((lambda *s: torch.randn(*s, dtype=torch.bfloat16) * 0.8)(D, Dh)),
            "wv": _w((lambda *s: torch.randn(*s, dtype=torch.bfloat16) * 0.05)(D, Dh)),
            "wo": _w((lambda *s: torch.randn(*s, dtype=torch.bfloat16) * 0.05)(H * Dh, D)),
        }
    _A_in = _A_setup()

    def _B_setup():
        B, S, D = 1, 2048, 512
        Df = D // 2 + 1
        return {
            "x": _w((lambda *s: torch.randn(*s, dtype=torch.bfloat16) * 0.05)(B, S, D)),
            "w_r": _w((lambda *s: torch.randn(*s, dtype=torch.bfloat16) * 0.4)(S, Df) * 0.02),
            "w_i": _w((lambda *s: torch.randn(*s, dtype=torch.bfloat16) * 0.4)(S, Df) * 0.02),
        }
    _B_in = _B_setup()

    return {
        "A_x": _A_in["x"],
        "A_wq": _A_in["wq"],
        "A_wk": _A_in["wk"],
        "A_wv": _A_in["wv"],
        "A_wo": _A_in["wo"],
        "B_x": _B_in["x"],
        "B_w_r": _B_in["w_r"],
        "B_w_i": _B_in["w_i"],
    }

def reference(A_x, A_wq, A_wk, A_wv, A_wo, B_x, B_w_r, B_w_i):
    def _A_ref(x, wq, wk, wv, wo):
        B, S, D = x.shape
        H = 32
        Dh = D // H
        q = (lambda x, *d: x.permute(*d))((x @ wq).reshape(B, S, H, Dh), 0, 2, 1, 3)
        k = x @ wk
        v = x @ wv
        scores = torch.einsum("bhqd,bkd->bhqk", q, k) * (Dh ** -0.5)
        p = _softmax(scores, axis=-1)
        o = torch.einsum("bhqk,bkd->bhqd", p, v)
        return (lambda x, *d: x.permute(*d))(o, 0, 2, 1, 3).reshape(B, S, H * Dh) @ wo

    def _B_ref(x, w_r, w_i):
        B, S, D = x.shape
        X = (lambda x, axes=(-2,-1): torch.fft.rfft2(x.float(), dim=axes))(x, axes=(-2, -1))
        W = w_r + 1j * w_i
        X = X * W
        y = (lambda x, s, axes=(-2,-1): torch.fft.irfft2(x, s=s, dim=axes).to(torch.bfloat16))(X, (S, D), axes=(-2, -1))
        return y

    a = _A_ref(A_x, A_wq, A_wk, A_wv, A_wo)
    b = _B_ref(B_x, B_w_r, B_w_i)
    return torch.concatenate([a, b], axis=-1)
```

```asm
; @launch kernel=k1_kernel grid=(256,1,1) block=(256,1,1) lds=163840
; @launch kernel=k2_kernel grid=(256,1,1) block=(512,1,1) lds=163840
.amdgcn_target "amdgcn-amd-amdhsa--gfx950"
.text
  .p2align 8
  .globl k1_kernel
  .type k1_kernel,@function
k1_kernel:
  s_cmp_ge_u32 s2, 256
  s_cbranch_scc1 .Lend_k1_kernel
  s_load_dwordx16 s[4:19], s[0:1], 0
  s_load_dwordx2 s[20:21], s[0:1], 64
  s_load_dwordx2 s[22:23], s[0:1], 80
  v_lshrrev_b32 v1, 6, v0
  v_and_b32 v0, 63, v0
  v_readfirstlane_b32 s3, v1
  s_and_b32 s40, s2, 7
  s_lshr_b32 s41, s2, 3
  s_lshr_b32 s45, s41, 3
  s_and_b32 s45, s45, 1
  s_lshl_b32 s46, s40, 1
  s_add_u32 s45, s45, s46
  s_and_b32 s44, s41, 7
  s_lshr_b32 s42, s3, 1
  s_and_b32 s43, s3, 1
  s_lshl_b32 s47, s3, 10
  s_waitcnt lgkmcnt(0)
  s_mov_b32 s24, s22
  s_mov_b32 s25, s23
  s_mov_b32 s26, 19922944
  s_mov_b32 s27, 0x00020000
  s_cmp_ge_u32 s41, 16
  s_cbranch_scc1 .Lk1_y
  s_mov_b32 s28, s4
  s_mov_b32 s29, s5
  s_mov_b32 s30, 2097152
  s_mov_b32 s31, 0x00020000
  s_mov_b32 s32, s6
  s_mov_b32 s33, s7
  s_mov_b32 s34, 524288
  s_mov_b32 s35, 0x00020000
  s_and_b32 s48, s44, 1
  s_cmp_eq_u32 s48, 0
  s_cselect_b32 s36, s8, s10
  s_cselect_b32 s37, s9, s11
  s_mov_b32 s38, 16384
  s_mov_b32 s39, 0x00020000
  v_lshrrev_b32 v2, 3, v0
  s_lshl_b32 s50, s3, 3
  v_add_u32 v2, s50, v2
  v_lshrrev_b32 v3, 1, v2
  v_xor_b32 v3, v3, v0
  v_and_b32 v3, 7, v3
  v_lshlrev_b32 v3, 4, v3
  v_lshl_add_u32 v10, v2, 10, v3
  s_lshl_b32 s50, s45, 17
  v_add_u32 v10, s50, v10
  v_lshlrev_b32 v12, 4, v0
  v_add_u32 v12, s47, v12
  v_lshrrev_b32 v2, 3, v0
  v_and_b32 v3, 7, v0
  v_lshrrev_b32 v4, 4, v0
  v_and_b32 v4, 1, v4
  v_lshlrev_b32 v4, 2, v4
  v_xor_b32 v3, v3, v4
  v_lshlrev_b32 v3, 4, v3
  v_lshl_add_u32 v11, v2, 10, v3
  s_lshl_b32 s50, s44, 7
  s_lshl_b32 s51, s3, 13
  s_add_u32 s50, s50, s51
  v_add_u32 v11, s50, v11
  s_mov_b32 s52, 0
  s_add_u32 m0, s47, 147456
  s_nop 0
  buffer_load_dwordx4 v12, s[36:39], s52 offen lds
  s_mov_b32 s52, 4096
  s_add_u32 m0, s47, 151552
  s_nop 0
  buffer_load_dwordx4 v12, s[36:39], s52 offen lds
  s_mov_b32 s52, 8192
  s_add_u32 m0, s47, 155648
  s_nop 0
  buffer_load_dwordx4 v12, s[36:39], s52 offen lds
  s_mov_b32 s52, 12288
  s_add_u32 m0, s47, 159744
  s_nop 0
  buffer_load_dwordx4 v12, s[36:39], s52 offen lds
  s_mov_b32 s52, 0
  s_add_u32 m0, s47, 0
  s_nop 0
  buffer_load_dwordx4 v10, s[28:31], s52 offen lds
  s_mov_b32 s52, 32768
  s_add_u32 m0, s47, 4096
  s_nop 0
  buffer_load_dwordx4 v10, s[28:31], s52 offen lds
  s_mov_b32 s52, 65536
  s_add_u32 m0, s47, 8192
  s_nop 0
  buffer_load_dwordx4 v10, s[28:31], s52 offen lds
  s_mov_b32 s52, 98304
  s_add_u32 m0, s47, 12288
  s_nop 0
  buffer_load_dwordx4 v10, s[28:31], s52 offen lds
  s_mov_b32 s52, 0
  s_add_u32 m0, s47, 16384
  s_nop 0
  buffer_load_dwordx4 v11, s[32:35], s52 offen lds
  s_mov_b32 s52, 32768
  s_add_u32 m0, s47, 20480
  s_nop 0
  buffer_load_dwordx4 v11, s[32:35], s52 offen lds
  s_mov_b32 s52, 128
  s_add_u32 m0, s47, 24576
  s_nop 0
  buffer_load_dwordx4 v10, s[28:31], s52 offen lds
  s_mov_b32 s52, 32896
  s_add_u32 m0, s47, 28672
  s_nop 0
  buffer_load_dwordx4 v10, s[28:31], s52 offen lds
  s_mov_b32 s52, 65664
  s_add_u32 m0, s47, 32768
  s_nop 0
  buffer_load_dwordx4 v10, s[28:31], s52 offen lds
  s_mov_b32 s52, 98432
  s_add_u32 m0, s47, 36864
  s_nop 0
  buffer_load_dwordx4 v10, s[28:31], s52 offen lds
  s_mov_b32 s52, 65536
  s_add_u32 m0, s47, 40960
  s_nop 0
  buffer_load_dwordx4 v11, s[32:35], s52 offen lds
  s_mov_b32 s52, 98304
  s_add_u32 m0, s47, 45056
  s_nop 0
  buffer_load_dwordx4 v11, s[32:35], s52 offen lds
  s_mov_b32 s52, 256
  s_add_u32 m0, s47, 49152
  s_nop 0
  buffer_load_dwordx4 v10, s[28:31], s52 offen lds
  s_mov_b32 s52, 33024
  s_add_u32 m0, s47, 53248
  s_nop 0
  buffer_load_dwordx4 v10, s[28:31], s52 offen lds
  s_mov_b32 s52, 65792
  s_add_u32 m0, s47, 57344
  s_nop 0
  buffer_load_dwordx4 v10, s[28:31], s52 offen lds
  s_mov_b32 s52, 98560
  s_add_u32 m0, s47, 61440
  s_nop 0
  buffer_load_dwordx4 v10, s[28:31], s52 offen lds
  s_mov_b32 s52, 131072
  s_add_u32 m0, s47, 65536
  s_nop 0
  buffer_load_dwordx4 v11, s[32:35], s52 offen lds
  s_mov_b32 s52, 163840
  s_add_u32 m0, s47, 69632
  s_nop 0
  buffer_load_dwordx4 v11, s[32:35], s52 offen lds
  v_lshrrev_b32 v2, 2, v0
  v_and_b32 v2, 3, v2
  v_lshrrev_b32 v3, 5, v0
  v_lshlrev_b32 v4, 3, v3
  v_add_u32 v4, v4, v2
  v_lshlrev_b32 v13, 7, v4
  v_lshrrev_b32 v2, 1, v2
  v_xor_b32 v2, s43, v2
  v_lshl_add_u32 v13, v2, 6, v13
  v_bfe_u32 v4, v0, 4, 1
  v_and_b32 v5, 3, v0
  v_lshl_add_u32 v5, v4, 2, v5
  v_lshl_add_u32 v13, v5, 3, v13
  v_and_b32 v2, 31, v0
  v_lshrrev_b32 v3, 5, v0
  v_bfe_u32 v4, v0, 1, 3
  v_xor_b32 v3, v3, v4
  v_lshlrev_b32 v3, 4, v3
  v_lshl_add_u32 v14, v2, 7, v3
  s_lshl_b32 s50, s42, 13
  v_add_u32 v14, s50, v14
  v_lshrrev_b32 v3, 5, v0
  v_lshrrev_b32 v2, 2, v0
  v_and_b32 v2, 3, v2
  v_lshl_add_u32 v2, v3, 3, v2
  v_and_b32 v3, 3, v0
  v_lshlrev_b32 v3, 3, v3
  v_lshl_add_u32 v15, v2, 5, v3
  v_add_u32 v15, 147456, v15
  s_lshr_b32 s50, s44, 2
  s_cmp_lg_u32 s50, s42
  s_cbranch_scc1 .Lk1_v0
  s_cmp_lg_u32 s48, s43
  s_cbranch_scc1 .Lk1_v0
  s_bfe_u32 s50, s44, 0x10001
  s_lshl_b32 s50, s50, 1
  s_add_u32 s50, s50, s48
  s_cmp_eq_u32 s50, 0
  s_cbranch_scc1 .Lk1_kv0
  s_cmp_eq_u32 s50, 1
  s_cbranch_scc1 .Lk1_kv1
  s_cmp_eq_u32 s50, 2
  s_cbranch_scc1 .Lk1_kv2
  s_cmp_eq_u32 s50, 3
  s_cbranch_scc1 .Lk1_kv3
.Lk1_v0:
  s_waitcnt vmcnt(12) lgkmcnt(0)
  s_barrier
  v_add_u32 v16, 0, v14
  v_add_u32 v17, 16384, v13
  v_xor_b32 v18, 32, v16
  v_xor_b32 v19, 64, v16
  v_xor_b32 v20, 96, v16
  ds_read_b64_tr_b16 v[80:81], v17 offset:0
  ds_read_b64_tr_b16 v[82:83], v17 offset:512
  ds_read_b128 v[84:87], v16
  ds_read_b128 v[88:91], v16 offset:4096
  s_mov_b32 s52, 384
  s_add_u32 m0, s47, 73728
  s_nop 0
  buffer_load_dwordx4 v10, s[28:31], s52 offen lds
  s_mov_b32 s52, 33152
  s_add_u32 m0, s47, 77824
  s_nop 0
  buffer_load_dwordx4 v10, s[28:31], s52 offen lds
  s_mov_b32 s52, 65920
  s_add_u32 m0, s47, 81920
  s_nop 0
  buffer_load_dwordx4 v10, s[28:31], s52 offen lds
  ds_read_b64_tr_b16 v[96:97], v17 offset:2048
  ds_read_b64_tr_b16 v[98:99], v17 offset:2560
  ds_read_b128 v[100:103], v18
  ds_read_b128 v[104:107], v18 offset:4096
  s_mov_b32 s52, 98688
  s_add_u32 m0, s47, 86016
  s_nop 0
  buffer_load_dwordx4 v10, s[28:31], s52 offen lds
  s_mov_b32 s52, 196608
  s_add_u32 m0, s47, 90112
  s_nop 0
  buffer_load_dwordx4 v11, s[32:35], s52 offen lds
  s_mov_b32 s52, 229376
  s_add_u32 m0, s47, 94208
  s_nop 0
  buffer_load_dwordx4 v11, s[32:35], s52 offen lds
  ds_read_b64_tr_b16 v[112:113], v17 offset:4096
  ds_read_b64_tr_b16 v[114:115], v17 offset:4608
  ds_read_b128 v[116:119], v19
  ds_read_b128 v[120:123], v19 offset:4096
  s_mov_b32 s52, 512
  s_add_u32 m0, s47, 98304
  s_nop 0
  buffer_load_dwordx4 v10, s[28:31], s52 offen lds
  s_mov_b32 s52, 33280
  s_add_u32 m0, s47, 102400
  s_nop 0
  buffer_load_dwordx4 v10, s[28:31], s52 offen lds
  s_mov_b32 s52, 66048
  s_add_u32 m0, s47, 106496
  s_nop 0
  buffer_load_dwordx4 v10, s[28:31], s52 offen lds
  ds_read_b64_tr_b16 v[128:129], v17 offset:6144
  ds_read_b64_tr_b16 v[130:131], v17 offset:6656
  ds_read_b128 v[132:135], v20
  ds_read_b128 v[136:139], v20 offset:4096
  s_mov_b32 s52, 98816
  s_add_u32 m0, s47, 110592
  s_nop 0
  buffer_load_dwordx4 v10, s[28:31], s52 offen lds
  s_mov_b32 s52, 262144
  s_add_u32 m0, s47, 114688
  s_nop 0
  buffer_load_dwordx4 v11, s[32:35], s52 offen lds
  s_mov_b32 s52, 294912
  s_add_u32 m0, s47, 118784
  s_nop 0
  buffer_load_dwordx4 v11, s[32:35], s52 offen lds
  s_waitcnt vmcnt(18) lgkmcnt(0)
  s_barrier
  v_add_u32 v16, 24576, v14
  v_add_u32 v17, 40960, v13
  v_xor_b32 v18, 32, v16
  v_xor_b32 v19, 64, v16
  v_xor_b32 v20, 96, v16
  ds_read_b64_tr_b16 v[144:145], v17 offset:0
  ds_read_b64_tr_b16 v[146:147], v17 offset:512
  ds_read_b128 v[148:151], v16
  ds_read_b128 v[152:155], v16 offset:4096
  v_mfma_f32_32x32x16_bf16 v[32:47], v[80:83], v[84:87], 0
  v_mfma_f32_32x32x16_bf16 v[48:63], v[80:83], v[88:91], 0
  s_mov_b32 s52, 640
  s_add_u32 m0, s47, 122880
  s_nop 0
  buffer_load_dwordx4 v10, s[28:31], s52 offen lds
  s_mov_b32 s52, 33408
  s_add_u32 m0, s47, 126976
  s_nop 0
  buffer_load_dwordx4 v10, s[28:31], s52 offen lds
  s_mov_b32 s52, 66176
  s_add_u32 m0, s47, 131072
  s_nop 0
  buffer_load_dwordx4 v10, s[28:31], s52 offen lds
  ds_read_b64_tr_b16 v[160:161], v17 offset:2048
  ds_read_b64_tr_b16 v[162:163], v17 offset:2560
  ds_read_b128 v[164:167], v18
  ds_read_b128 v[168:171], v18 offset:4096
  v_mfma_f32_32x32x16_bf16 v[32:47], v[96:99], v[100:103], v[32:47]
  v_mfma_f32_32x32x16_bf16 v[48:63], v[96:99], v[104:107], v[48:63]
  s_mov_b32 s52, 98944
  s_add_u32 m0, s47, 135168
  s_nop 0
  buffer_load_dwordx4 v10, s[28:31], s52 offen lds
  s_mov_b32 s52, 327680
  s_add_u32 m0, s47, 139264
  s_nop 0
  buffer_load_dwordx4 v11, s[32:35], s52 offen lds
  s_mov_b32 s52, 360448
  s_add_u32 m0, s47, 143360
  s_nop 0
  buffer_load_dwordx4 v11, s[32:35], s52 offen lds
  ds_read_b64_tr_b16 v[176:177], v17 offset:4096
  ds_read_b64_tr_b16 v[178:179], v17 offset:4608
  ds_read_b128 v[180:183], v19
  ds_read_b128 v[184:187], v19 offset:4096
  v_mfma_f32_32x32x16_bf16 v[32:47], v[112:115], v[116:119], v[32:47]
  v_mfma_f32_32x32x16_bf16 v[48:63], v[112:115], v[120:123], v[48:63]
  s_mov_b32 s52, 768
  s_add_u32 m0, s47, 0
  s_nop 0
  buffer_load_dwordx4 v10, s[28:31], s52 offen lds
  s_mov_b32 s52, 33536
  s_add_u32 m0, s47, 4096
  s_nop 0
  buffer_load_dwordx4 v10, s[28:31], s52 offen lds
  s_mov_b32 s52, 66304
  s_add_u32 m0, s47, 8192
  s_nop 0
  buffer_load_dwordx4 v10, s[28:31], s52 offen lds
  ds_read_b64_tr_b16 v[192:193], v17 offset:6144
  ds_read_b64_tr_b16 v[194:195], v17 offset:6656
  ds_read_b128 v[196:199], v20
  ds_read_b128 v[200:203], v20 offset:4096
  v_mfma_f32_32x32x16_bf16 v[32:47], v[128:131], v[132:135], v[32:47]
  v_mfma_f32_32x32x16_bf16 v[48:63], v[128:131], v[136:139], v[48:63]
  s_mov_b32 s52, 99072
  s_add_u32 m0, s47, 12288
  s_nop 0
  buffer_load_dwordx4 v10, s[28:31], s52 offen lds
  s_mov_b32 s52, 393216
  s_add_u32 m0, s47, 16384
  s_nop 0
  buffer_load_dwordx4 v11, s[32:35], s52 offen lds
  s_mov_b32 s52, 425984
  s_add_u32 m0, s47, 20480
  s_nop 0
  buffer_load_dwordx4 v11, s[32:35], s52 offen lds
  s_waitcnt vmcnt(24) lgkmcnt(0)
  s_barrier
  v_add_u32 v16, 49152, v14
  v_add_u32 v17, 65536, v13
  v_xor_b32 v18, 32, v16
  v_xor_b32 v19, 64, v16
  v_xor_b32 v20, 96, v16
  ds_read_b64_tr_b16 v[80:81], v17 offset:0
  ds_read_b64_tr_b16 v[82:83], v17 offset:512
  ds_read_b128 v[84:87], v16
  ds_read_b128 v[88:91], v16 offset:4096
  v_mfma_f32_32x32x16_bf16 v[32:47], v[144:147], v[148:151], v[32:47]
  v_mfma_f32_32x32x16_bf16 v[48:63], v[144:147], v[152:155], v[48:63]
  s_mov_b32 s52, 896
  s_add_u32 m0, s47, 24576
  s_nop 0
  buffer_load_dwordx4 v10, s[28:31], s52 offen lds
  s_mov_b32 s52, 33664
  s_add_u32 m0, s47, 28672
  s_nop 0
  buffer_load_dwordx4 v10, s[28:31], s52 offen lds
  ds_read_b64_tr_b16 v[96:97], v17 offset:2048
  ds_read_b64_tr_b16 v[98:99], v17 offset:2560
  ds_read_b128 v[100:103], v18
  ds_read_b128 v[104:107], v18 offset:4096
  v_mfma_f32_32x32x16_bf16 v[32:47], v[160:163], v[164:167], v[32:47]
  v_mfma_f32_32x32x16_bf16 v[48:63], v[160:163], v[168:171], v[48:63]
  s_mov_b32 s52, 66432
  s_add_u32 m0, s47, 32768
  s_nop 0
  buffer_load_dwordx4 v10, s[28:31], s52 offen lds
  s_mov_b32 s52, 99200
  s_add_u32 m0, s47, 36864
  s_nop 0
  buffer_load_dwordx4 v10, s[28:31], s52 offen lds
  ds_read_b64_tr_b16 v[112:113], v17 offset:4096
  ds_read_b64_tr_b16 v[114:115], v17 offset:4608
  ds_read_b128 v[116:119], v19
  ds_read_b128 v[120:123], v19 offset:4096
  v_mfma_f32_32x32x16_bf16 v[32:47], v[176:179], v[180:183], v[32:47]
  v_mfma_f32_32x32x16_bf16 v[48:63], v[176:179], v[184:187], v[48:63]
  s_mov_b32 s52, 458752
  s_add_u32 m0, s47, 40960
  s_nop 0
  buffer_load_dwordx4 v11, s[32:35], s52 offen lds
  s_mov_b32 s52, 491520
  s_add_u32 m0, s47, 45056
  s_nop 0
  buffer_load_dwordx4 v11, s[32:35], s52 offen lds
  ds_read_b64_tr_b16 v[128:129], v17 offset:6144
  ds_read_b64_tr_b16 v[130:131], v17 offset:6656
  ds_read_b128 v[132:135], v20
  ds_read_b128 v[136:139], v20 offset:4096
  v_mfma_f32_32x32x16_bf16 v[32:47], v[192:195], v[196:199], v[32:47]
  v_mfma_f32_32x32x16_bf16 v[48:63], v[192:195], v[200:203], v[48:63]
  s_waitcnt vmcnt(24) lgkmcnt(0)
  s_barrier
  v_add_u32 v16, 73728, v14
  v_add_u32 v17, 90112, v13
  v_xor_b32 v18, 32, v16
  v_xor_b32 v19, 64, v16
  v_xor_b32 v20, 96, v16
  ds_read_b64_tr_b16 v[144:145], v17 offset:0
  ds_read_b64_tr_b16 v[146:147], v17 offset:512
  ds_read_b128 v[148:151], v16
  ds_read_b128 v[152:155], v16 offset:4096
  v_mfma_f32_32x32x16_bf16 v[32:47], v[80:83], v[84:87], v[32:47]
  v_mfma_f32_32x32x16_bf16 v[48:63], v[80:83], v[88:91], v[48:63]
  ds_read_b64_tr_b16 v[160:161], v17 offset:2048
  ds_read_b64_tr_b16 v[162:163], v17 offset:2560
  ds_read_b128 v[164:167], v18
  ds_read_b128 v[168:171], v18 offset:4096
  v_mfma_f32_32x32x16_bf16 v[32:47], v[96:99], v[100:103], v[32:47]
  v_mfma_f32_32x32x16_bf16 v[48:63], v[96:99], v[104:107], v[48:63]
  ds_read_b64_tr_b16 v[176:177], v17 offset:4096
  ds_read_b64_tr_b16 v[178:179], v17 offset:4608
  ds_read_b128 v[180:183], v19
  ds_read_b128 v[184:187], v19 offset:4096
  v_mfma_f32_32x32x16_bf16 v[32:47], v[112:115], v[116:119], v[32:47]
  v_mfma_f32_32x32x16_bf16 v[48:63], v[112:115], v[120:123], v[48:63]
  ds_read_b64_tr_b16 v[192:193], v17 offset:6144
  ds_read_b64_tr_b16 v[194:195], v17 offset:6656
  ds_read_b128 v[196:199], v20
  ds_read_b128 v[200:203], v20 offset:4096
  v_mfma_f32_32x32x16_bf16 v[32:47], v[128:131], v[132:135], v[32:47]
  v_mfma_f32_32x32x16_bf16 v[48:63], v[128:131], v[136:139], v[48:63]
  s_waitcnt vmcnt(18) lgkmcnt(0)
  s_barrier
  v_add_u32 v16, 98304, v14
  v_add_u32 v17, 114688, v13
  v_xor_b32 v18, 32, v16
  v_xor_b32 v19, 64, v16
  v_xor_b32 v20, 96, v16
  ds_read_b64_tr_b16 v[80:81], v17 offset:0
  ds_read_b64_tr_b16 v[82:83], v17 offset:512
  ds_read_b128 v[84:87], v16
  ds_read_b128 v[88:91], v16 offset:4096
  v_mfma_f32_32x32x16_bf16 v[32:47], v[144:147], v[148:151], v[32:47]
  v_mfma_f32_32x32x16_bf16 v[48:63], v[144:147], v[152:155], v[48:63]
  ds_read_b64_tr_b16 v[96:97], v17 offset:2048
  ds_read_b64_tr_b16 v[98:99], v17 offset:2560
  ds_read_b128 v[100:103], v18
  ds_read_b128 v[104:107], v18 offset:4096
  v_mfma_f32_32x32x16_bf16 v[32:47], v[160:163], v[164:167], v[32:47]
  v_mfma_f32_32x32x16_bf16 v[48:63], v[160:163], v[168:171], v[48:63]
  ds_read_b64_tr_b16 v[112:113], v17 offset:4096
  ds_read_b64_tr_b16 v[114:115], v17 offset:4608
  ds_read_b128 v[116:119], v19
  ds_read_b128 v[120:123], v19 offset:4096
  v_mfma_f32_32x32x16_bf16 v[32:47], v[176:179], v[180:183], v[32:47]
  v_mfma_f32_32x32x16_bf16 v[48:63], v[176:179], v[184:187], v[48:63]
  ds_read_b64_tr_b16 v[128:129], v17 offset:6144
  ds_read_b64_tr_b16 v[130:131], v17 offset:6656
  ds_read_b128 v[132:135], v20
  ds_read_b128 v[136:139], v20 offset:4096
  v_mfma_f32_32x32x16_bf16 v[32:47], v[192:195], v[196:199], v[32:47]
  v_mfma_f32_32x32x16_bf16 v[48:63], v[192:195], v[200:203], v[48:63]
  s_waitcnt vmcnt(12) lgkmcnt(0)
  s_barrier
  v_add_u32 v16, 122880, v14
  v_add_u32 v17, 139264, v13
  v_xor_b32 v18, 32, v16
  v_xor_b32 v19, 64, v16
  v_xor_b32 v20, 96, v16
  ds_read_b64_tr_b16 v[144:145], v17 offset:0
  ds_read_b64_tr_b16 v[146:147], v17 offset:512
  ds_read_b128 v[148:151], v16
  ds_read_b128 v[152:155], v16 offset:4096
  v_mfma_f32_32x32x16_bf16 v[32:47], v[80:83], v[84:87], v[32:47]
  v_mfma_f32_32x32x16_bf16 v[48:63], v[80:83], v[88:91], v[48:63]
  ds_read_b64_tr_b16 v[160:161], v17 offset:2048
  ds_read_b64_tr_b16 v[162:163], v17 offset:2560
  ds_read_b128 v[164:167], v18
  ds_read_b128 v[168:171], v18 offset:4096
  v_mfma_f32_32x32x16_bf16 v[32:47], v[96:99], v[100:103], v[32:47]
  v_mfma_f32_32x32x16_bf16 v[48:63], v[96:99], v[104:107], v[48:63]
  ds_read_b64_tr_b16 v[176:177], v17 offset:4096
  ds_read_b64_tr_b16 v[178:179], v17 offset:4608
  ds_read_b128 v[180:183], v19
  ds_read_b128 v[184:187], v19 offset:4096
  v_mfma_f32_32x32x16_bf16 v[32:47], v[112:115], v[116:119], v[32:47]
  v_mfma_f32_32x32x16_bf16 v[48:63], v[112:115], v[120:123], v[48:63]
  ds_read_b64_tr_b16 v[192:193], v17 offset:6144
  ds_read_b64_tr_b16 v[194:195], v17 offset:6656
  ds_read_b128 v[196:199], v20
  ds_read_b128 v[200:203], v20 offset:4096
  v_mfma_f32_32x32x16_bf16 v[32:47], v[128:131], v[132:135], v[32:47]
  v_mfma_f32_32x32x16_bf16 v[48:63], v[128:131], v[136:139], v[48:63]
  s_waitcnt vmcnt(6) lgkmcnt(0)
  s_barrier
  v_add_u32 v16, 0, v14
  v_add_u32 v17, 16384, v13
  v_xor_b32 v18, 32, v16
  v_xor_b32 v19, 64, v16
  v_xor_b32 v20, 96, v16
  ds_read_b64_tr_b16 v[80:81], v17 offset:0
  ds_read_b64_tr_b16 v[82:83], v17 offset:512
  ds_read_b128 v[84:87], v16
  ds_read_b128 v[88:91], v16 offset:4096
  v_mfma_f32_32x32x16_bf16 v[32:47], v[144:147], v[148:151], v[32:47]
  v_mfma_f32_32x32x16_bf16 v[48:63], v[144:147], v[152:155], v[48:63]
  ds_read_b64_tr_b16 v[96:97], v17 offset:2048
  ds_read_b64_tr_b16 v[98:99], v17 offset:2560
  ds_read_b128 v[100:103], v18
  ds_read_b128 v[104:107], v18 offset:4096
  v_mfma_f32_32x32x16_bf16 v[32:47], v[160:163], v[164:167], v[32:47]
  v_mfma_f32_32x32x16_bf16 v[48:63], v[160:163], v[168:171], v[48:63]
  ds_read_b64_tr_b16 v[112:113], v17 offset:4096
  ds_read_b64_tr_b16 v[114:115], v17 offset:4608
  ds_read_b128 v[116:119], v19
  ds_read_b128 v[120:123], v19 offset:4096
  v_mfma_f32_32x32x16_bf16 v[32:47], v[176:179], v[180:183], v[32:47]
  v_mfma_f32_32x32x16_bf16 v[48:63], v[176:179], v[184:187], v[48:63]
  ds_read_b64_tr_b16 v[128:129], v17 offset:6144
  ds_read_b64_tr_b16 v[130:131], v17 offset:6656
  ds_read_b128 v[132:135], v20
  ds_read_b128 v[136:139], v20 offset:4096
  v_mfma_f32_32x32x16_bf16 v[32:47], v[192:195], v[196:199], v[32:47]
  v_mfma_f32_32x32x16_bf16 v[48:63], v[192:195], v[200:203], v[48:63]
  s_waitcnt vmcnt(0) lgkmcnt(0)
  s_barrier
  v_add_u32 v16, 24576, v14
  v_add_u32 v17, 40960, v13
  v_xor_b32 v18, 32, v16
  v_xor_b32 v19, 64, v16
  v_xor_b32 v20, 96, v16
  ds_read_b64_tr_b16 v[144:145], v17 offset:0
  ds_read_b64_tr_b16 v[146:147], v17 offset:512
  ds_read_b128 v[148:151], v16
  ds_read_b128 v[152:155], v16 offset:4096
  v_mfma_f32_32x32x16_bf16 v[32:47], v[80:83], v[84:87], v[32:47]
  v_mfma_f32_32x32x16_bf16 v[48:63], v[80:83], v[88:91], v[48:63]
  ds_read_b64_tr_b16 v[160:161], v17 offset:2048
  ds_read_b64_tr_b16 v[162:163], v17 offset:2560
  ds_read_b128 v[164:167], v18
  ds_read_b128 v[168:171], v18 offset:4096
  v_mfma_f32_32x32x16_bf16 v[32:47], v[96:99], v[100:103], v[32:47]
  v_mfma_f32_32x32x16_bf16 v[48:63], v[96:99], v[104:107], v[48:63]
  ds_read_b64_tr_b16 v[176:177], v17 offset:4096
  ds_read_b64_tr_b16 v[178:179], v17 offset:4608
  ds_read_b128 v[180:183], v19
  ds_read_b128 v[184:187], v19 offset:4096
  v_mfma_f32_32x32x16_bf16 v[32:47], v[112:115], v[116:119], v[32:47]
  v_mfma_f32_32x32x16_bf16 v[48:63], v[112:115], v[120:123], v[48:63]
  ds_read_b64_tr_b16 v[192:193], v17 offset:6144
  ds_read_b64_tr_b16 v[194:195], v17 offset:6656
  ds_read_b128 v[196:199], v20
  ds_read_b128 v[200:203], v20 offset:4096
  v_mfma_f32_32x32x16_bf16 v[32:47], v[128:131], v[132:135], v[32:47]
  v_mfma_f32_32x32x16_bf16 v[48:63], v[128:131], v[136:139], v[48:63]
  s_waitcnt lgkmcnt(12)
  v_mfma_f32_32x32x16_bf16 v[32:47], v[144:147], v[148:151], v[32:47]
  v_mfma_f32_32x32x16_bf16 v[48:63], v[144:147], v[152:155], v[48:63]
  s_waitcnt lgkmcnt(8)
  v_mfma_f32_32x32x16_bf16 v[32:47], v[160:163], v[164:167], v[32:47]
  v_mfma_f32_32x32x16_bf16 v[48:63], v[160:163], v[168:171], v[48:63]
  s_waitcnt lgkmcnt(4)
  v_mfma_f32_32x32x16_bf16 v[32:47], v[176:179], v[180:183], v[32:47]
  v_mfma_f32_32x32x16_bf16 v[48:63], v[176:179], v[184:187], v[48:63]
  s_waitcnt lgkmcnt(0)
  v_mfma_f32_32x32x16_bf16 v[32:47], v[192:195], v[196:199], v[32:47]
  v_mfma_f32_32x32x16_bf16 v[48:63], v[192:195], v[200:203], v[48:63]
  s_branch .Lk1_qepi
.Lk1_kv0:
  s_waitcnt vmcnt(12) lgkmcnt(0)
  s_barrier
  v_add_u32 v16, 0, v14
  v_add_u32 v17, 16384, v13
  v_xor_b32 v18, 32, v16
  v_xor_b32 v19, 64, v16
  v_xor_b32 v20, 96, v16
  ds_read_b64_tr_b16 v[80:81], v17 offset:0
  ds_read_b64_tr_b16 v[82:83], v17 offset:512
  ds_read_b128 v[84:87], v16
  ds_read_b128 v[88:91], v16 offset:4096
  ds_read_b64_tr_b16 v[92:93], v15 offset:0
  ds_read_b64_tr_b16 v[94:95], v15 offset:128
  s_mov_b32 s52, 384
  s_add_u32 m0, s47, 73728
  s_nop 0
  buffer_load_dwordx4 v10, s[28:31], s52 offen lds
  s_mov_b32 s52, 33152
  s_add_u32 m0, s47, 77824
  s_nop 0
  buffer_load_dwordx4 v10, s[28:31], s52 offen lds
  s_mov_b32 s52, 65920
  s_add_u32 m0, s47, 81920
  s_nop 0
  buffer_load_dwordx4 v10, s[28:31], s52 offen lds
  ds_read_b64_tr_b16 v[96:97], v17 offset:2048
  ds_read_b64_tr_b16 v[98:99], v17 offset:2560
  ds_read_b128 v[100:103], v18
  ds_read_b128 v[104:107], v18 offset:4096
  ds_read_b64_tr_b16 v[108:109], v15 offset:512
  ds_read_b64_tr_b16 v[110:111], v15 offset:640
  s_mov_b32 s52, 98688
  s_add_u32 m0, s47, 86016
  s_nop 0
  buffer_load_dwordx4 v10, s[28:31], s52 offen lds
  s_mov_b32 s52, 196608
  s_add_u32 m0, s47, 90112
  s_nop 0
  buffer_load_dwordx4 v11, s[32:35], s52 offen lds
  s_mov_b32 s52, 229376
  s_add_u32 m0, s47, 94208
  s_nop 0
  buffer_load_dwordx4 v11, s[32:35], s52 offen lds
  ds_read_b64_tr_b16 v[112:113], v17 offset:4096
  ds_read_b64_tr_b16 v[114:115], v17 offset:4608
  ds_read_b128 v[116:119], v19
  ds_read_b128 v[120:123], v19 offset:4096
  ds_read_b64_tr_b16 v[124:125], v15 offset:1024
  ds_read_b64_tr_b16 v[126:127], v15 offset:1152
  s_mov_b32 s52, 512
  s_add_u32 m0, s47, 98304
  s_nop 0
  buffer_load_dwordx4 v10, s[28:31], s52 offen lds
  s_mov_b32 s52, 33280
  s_add_u32 m0, s47, 102400
  s_nop 0
  buffer_load_dwordx4 v10, s[28:31], s52 offen lds
  s_mov_b32 s52, 66048
  s_add_u32 m0, s47, 106496
  s_nop 0
  buffer_load_dwordx4 v10, s[28:31], s52 offen lds
  ds_read_b64_tr_b16 v[128:129], v17 offset:6144
  ds_read_b64_tr_b16 v[130:131], v17 offset:6656
  ds_read_b128 v[132:135], v20
  ds_read_b128 v[136:139], v20 offset:4096
  ds_read_b64_tr_b16 v[140:141], v15 offset:1536
  ds_read_b64_tr_b16 v[142:143], v15 offset:1664
  s_mov_b32 s52, 98816
  s_add_u32 m0, s47, 110592
  s_nop 0
  buffer_load_dwordx4 v10, s[28:31], s52 offen lds
  s_mov_b32 s52, 262144
  s_add_u32 m0, s47, 114688
  s_nop 0
  buffer_load_dwordx4 v11, s[32:35], s52 offen lds
  s_mov_b32 s52, 294912
  s_add_u32 m0, s47, 118784
  s_nop 0
  buffer_load_dwordx4 v11, s[32:35], s52 offen lds
  s_waitcnt vmcnt(18) lgkmcnt(0)
  s_barrier
  v_add_u32 v16, 24576, v14
  v_add_u32 v17, 40960, v13
  v_xor_b32 v18, 32, v16
  v_xor_b32 v19, 64, v16
  v_xor_b32 v20, 96, v16
  ds_read_b64_tr_b16 v[144:145], v17 offset:0
  ds_read_b64_tr_b16 v[146:147], v17 offset:512
  ds_read_b128 v[148:151], v16
  ds_read_b128 v[152:155], v16 offset:4096
  ds_read_b64_tr_b16 v[156:157], v15 offset:2048
  ds_read_b64_tr_b16 v[158:159], v15 offset:2176
  v_mfma_f32_32x32x16_bf16 v[32:47], v[80:83], v[84:87], 0
  v_mfma_f32_32x32x16_bf16 v[48:63], v[80:83], v[88:91], 0
  v_mfma_f32_32x32x16_bf16 v[64:79], v[92:95], v[84:87], 0
  s_mov_b32 s52, 640
  s_add_u32 m0, s47, 122880
  s_nop 0
  buffer_load_dwordx4 v10, s[28:31], s52 offen lds
  s_mov_b32 s52, 33408
  s_add_u32 m0, s47, 126976
  s_nop 0
  buffer_load_dwordx4 v10, s[28:31], s52 offen lds
  s_mov_b32 s52, 66176
  s_add_u32 m0, s47, 131072
  s_nop 0
  buffer_load_dwordx4 v10, s[28:31], s52 offen lds
  ds_read_b64_tr_b16 v[160:161], v17 offset:2048
  ds_read_b64_tr_b16 v[162:163], v17 offset:2560
  ds_read_b128 v[164:167], v18
  ds_read_b128 v[168:171], v18 offset:4096
  ds_read_b64_tr_b16 v[172:173], v15 offset:2560
  ds_read_b64_tr_b16 v[174:175], v15 offset:2688
  v_mfma_f32_32x32x16_bf16 v[32:47], v[96:99], v[100:103], v[32:47]
  v_mfma_f32_32x32x16_bf16 v[48:63], v[96:99], v[104:107], v[48:63]
  v_mfma_f32_32x32x16_bf16 v[64:79], v[108:111], v[100:103], v[64:79]
  s_mov_b32 s52, 98944
  s_add_u32 m0, s47, 135168
  s_nop 0
  buffer_load_dwordx4 v10, s[28:31], s52 offen lds
  s_mov_b32 s52, 327680
  s_add_u32 m0, s47, 139264
  s_nop 0
  buffer_load_dwordx4 v11, s[32:35], s52 offen lds
  s_mov_b32 s52, 360448
  s_add_u32 m0, s47, 143360
  s_nop 0
  buffer_load_dwordx4 v11, s[32:35], s52 offen lds
  ds_read_b64_tr_b16 v[176:177], v17 offset:4096
  ds_read_b64_tr_b16 v[178:179], v17 offset:4608
  ds_read_b128 v[180:183], v19
  ds_read_b128 v[184:187], v19 offset:4096
  ds_read_b64_tr_b16 v[188:189], v15 offset:3072
  ds_read_b64_tr_b16 v[190:191], v15 offset:3200
  v_mfma_f32_32x32x16_bf16 v[32:47], v[112:115], v[116:119], v[32:47]
  v_mfma_f32_32x32x16_bf16 v[48:63], v[112:115], v[120:123], v[48:63]
  v_mfma_f32_32x32x16_bf16 v[64:79], v[124:127], v[116:119], v[64:79]
  s_mov_b32 s52, 768
  s_add_u32 m0, s47, 0
  s_nop 0
  buffer_load_dwordx4 v10, s[28:31], s52 offen lds
  s_mov_b32 s52, 33536
  s_add_u32 m0, s47, 4096
  s_nop 0
  buffer_load_dwordx4 v10, s[28:31], s52 offen lds
  s_mov_b32 s52, 66304
  s_add_u32 m0, s47, 8192
  s_nop 0
  buffer_load_dwordx4 v10, s[28:31], s52 offen lds
  ds_read_b64_tr_b16 v[192:193], v17 offset:6144
  ds_read_b64_tr_b16 v[194:195], v17 offset:6656
  ds_read_b128 v[196:199], v20
  ds_read_b128 v[200:203], v20 offset:4096
  ds_read_b64_tr_b16 v[204:205], v15 offset:3584
  ds_read_b64_tr_b16 v[206:207], v15 offset:3712
  v_mfma_f32_32x32x16_bf16 v[32:47], v[128:131], v[132:135], v[32:47]
  v_mfma_f32_32x32x16_bf16 v[48:63], v[128:131], v[136:139], v[48:63]
  v_mfma_f32_32x32x16_bf16 v[64:79], v[140:143], v[132:135], v[64:79]
  s_mov_b32 s52, 99072
  s_add_u32 m0, s47, 12288
  s_nop 0
  buffer_load_dwordx4 v10, s[28:31], s52 offen lds
  s_mov_b32 s52, 393216
  s_add_u32 m0, s47, 16384
  s_nop 0
  buffer_load_dwordx4 v11, s[32:35], s52 offen lds
  s_mov_b32 s52, 425984
  s_add_u32 m0, s47, 20480
  s_nop 0
  buffer_load_dwordx4 v11, s[32:35], s52 offen lds
  s_waitcnt vmcnt(24) lgkmcnt(0)
  s_barrier
  v_add_u32 v16, 49152, v14
  v_add_u32 v17, 65536, v13
  v_xor_b32 v18, 32, v16
  v_xor_b32 v19, 64, v16
  v_xor_b32 v20, 96, v16
  ds_read_b64_tr_b16 v[80:81], v17 offset:0
  ds_read_b64_tr_b16 v[82:83], v17 offset:512
  ds_read_b128 v[84:87], v16
  ds_read_b128 v[88:91], v16 offset:4096
  ds_read_b64_tr_b16 v[92:93], v15 offset:4096
  ds_read_b64_tr_b16 v[94:95], v15 offset:4224
  v_mfma_f32_32x32x16_bf16 v[32:47], v[144:147], v[148:151], v[32:47]
  v_mfma_f32_32x32x16_bf16 v[48:63], v[144:147], v[152:155], v[48:63]
  v_mfma_f32_32x32x16_bf16 v[64:79], v[156:159], v[148:151], v[64:79]
  s_mov_b32 s52, 896
  s_add_u32 m0, s47, 24576
  s_nop 0
  buffer_load_dwordx4 v10, s[28:31], s52 offen lds
  s_mov_b32 s52, 33664
  s_add_u32 m0, s47, 28672
  s_nop 0
  buffer_load_dwordx4 v10, s[28:31], s52 offen lds
  ds_read_b64_tr_b16 v[96:97], v17 offset:2048
  ds_read_b64_tr_b16 v[98:99], v17 offset:2560
  ds_read_b128 v[100:103], v18
  ds_read_b128 v[104:107], v18 offset:4096
  ds_read_b64_tr_b16 v[108:109], v15 offset:4608
  ds_read_b64_tr_b16 v[110:111], v15 offset:4736
  v_mfma_f32_32x32x16_bf16 v[32:47], v[160:163], v[164:167], v[32:47]
  v_mfma_f32_32x32x16_bf16 v[48:63], v[160:163], v[168:171], v[48:63]
  v_mfma_f32_32x32x16_bf16 v[64:79], v[172:175], v[164:167], v[64:79]
  s_mov_b32 s52, 66432
  s_add_u32 m0, s47, 32768
  s_nop 0
  buffer_load_dwordx4 v10, s[28:31], s52 offen lds
  s_mov_b32 s52, 99200
  s_add_u32 m0, s47, 36864
  s_nop 0
  buffer_load_dwordx4 v10, s[28:31], s52 offen lds
  ds_read_b64_tr_b16 v[112:113], v17 offset:4096
  ds_read_b64_tr_b16 v[114:115], v17 offset:4608
  ds_read_b128 v[116:119], v19
  ds_read_b128 v[120:123], v19 offset:4096
  ds_read_b64_tr_b16 v[124:125], v15 offset:5120
  ds_read_b64_tr_b16 v[126:127], v15 offset:5248
  v_mfma_f32_32x32x16_bf16 v[32:47], v[176:179], v[180:183], v[32:47]
  v_mfma_f32_32x32x16_bf16 v[48:63], v[176:179], v[184:187], v[48:63]
  v_mfma_f32_32x32x16_bf16 v[64:79], v[188:191], v[180:183], v[64:79]
  s_mov_b32 s52, 458752
  s_add_u32 m0, s47, 40960
  s_nop 0
  buffer_load_dwordx4 v11, s[32:35], s52 offen lds
  s_mov_b32 s52, 491520
  s_add_u32 m0, s47, 45056
  s_nop 0
  buffer_load_dwordx4 v11, s[32:35], s52 offen lds
  ds_read_b64_tr_b16 v[128:129], v17 offset:6144
  ds_read_b64_tr_b16 v[130:131], v17 offset:6656
  ds_read_b128 v[132:135], v20
  ds_read_b128 v[136:139], v20 offset:4096
  ds_read_b64_tr_b16 v[140:141], v15 offset:5632
  ds_read_b64_tr_b16 v[142:143], v15 offset:5760
  v_mfma_f32_32x32x16_bf16 v[32:47], v[192:195], v[196:199], v[32:47]
  v_mfma_f32_32x32x16_bf16 v[48:63], v[192:195], v[200:203], v[48:63]
  v_mfma_f32_32x32x16_bf16 v[64:79], v[204:207], v[196:199], v[64:79]
  s_waitcnt vmcnt(24) lgkmcnt(0)
  s_barrier
  v_add_u32 v16, 73728, v14
  v_add_u32 v17, 90112, v13
  v_xor_b32 v18, 32, v16
  v_xor_b32 v19, 64, v16
  v_xor_b32 v20, 96, v16
  ds_read_b64_tr_b16 v[144:145], v17 offset:0
  ds_read_b64_tr_b16 v[146:147], v17 offset:512
  ds_read_b128 v[148:151], v16
  ds_read_b128 v[152:155], v16 offset:4096
  ds_read_b64_tr_b16 v[156:157], v15 offset:6144
  ds_read_b64_tr_b16 v[158:159], v15 offset:6272
  v_mfma_f32_32x32x16_bf16 v[32:47], v[80:83], v[84:87], v[32:47]
  v_mfma_f32_32x32x16_bf16 v[48:63], v[80:83], v[88:91], v[48:63]
  v_mfma_f32_32x32x16_bf16 v[64:79], v[92:95], v[84:87], v[64:79]
  ds_read_b64_tr_b16 v[160:161], v17 offset:2048
  ds_read_b64_tr_b16 v[162:163], v17 offset:2560
  ds_read_b128 v[164:167], v18
  ds_read_b128 v[168:171], v18 offset:4096
  ds_read_b64_tr_b16 v[172:173], v15 offset:6656
  ds_read_b64_tr_b16 v[174:175], v15 offset:6784
  v_mfma_f32_32x32x16_bf16 v[32:47], v[96:99], v[100:103], v[32:47]
  v_mfma_f32_32x32x16_bf16 v[48:63], v[96:99], v[104:107], v[48:63]
  v_mfma_f32_32x32x16_bf16 v[64:79], v[108:111], v[100:103], v[64:79]
  ds_read_b64_tr_b16 v[176:177], v17 offset:4096
  ds_read_b64_tr_b16 v[178:179], v17 offset:4608
  ds_read_b128 v[180:183], v19
  ds_read_b128 v[184:187], v19 offset:4096
  ds_read_b64_tr_b16 v[188:189], v15 offset:7168
  ds_read_b64_tr_b16 v[190:191], v15 offset:7296
  v_mfma_f32_32x32x16_bf16 v[32:47], v[112:115], v[116:119], v[32:47]
  v_mfma_f32_32x32x16_bf16 v[48:63], v[112:115], v[120:123], v[48:63]
  v_mfma_f32_32x32x16_bf16 v[64:79], v[124:127], v[116:119], v[64:79]
  ds_read_b64_tr_b16 v[192:193], v17 offset:6144
  ds_read_b64_tr_b16 v[194:195], v17 offset:6656
  ds_read_b128 v[196:199], v20
  ds_read_b128 v[200:203], v20 offset:4096
  ds_read_b64_tr_b16 v[204:205], v15 offset:7680
  ds_read_b64_tr_b16 v[206:207], v15 offset:7808
  v_mfma_f32_32x32x16_bf16 v[32:47], v[128:131], v[132:135], v[32:47]
  v_mfma_f32_32x32x16_bf16 v[48:63], v[128:131], v[136:139], v[48:63]
  v_mfma_f32_32x32x16_bf16 v[64:79], v[140:143], v[132:135], v[64:79]
  s_waitcnt vmcnt(18) lgkmcnt(0)
  s_barrier
  v_add_u32 v16, 98304, v14
  v_add_u32 v17, 114688, v13
  v_xor_b32 v18, 32, v16
  v_xor_b32 v19, 64, v16
  v_xor_b32 v20, 96, v16
  ds_read_b64_tr_b16 v[80:81], v17 offset:0
  ds_read_b64_tr_b16 v[82:83], v17 offset:512
  ds_read_b128 v[84:87], v16
  ds_read_b128 v[88:91], v16 offset:4096
  ds_read_b64_tr_b16 v[92:93], v15 offset:8192
  ds_read_b64_tr_b16 v[94:95], v15 offset:8320
  v_mfma_f32_32x32x16_bf16 v[32:47], v[144:147], v[148:151], v[32:47]
  v_mfma_f32_32x32x16_bf16 v[48:63], v[144:147], v[152:155], v[48:63]
  v_mfma_f32_32x32x16_bf16 v[64:79], v[156:159], v[148:151], v[64:79]
  ds_read_b64_tr_b16 v[96:97], v17 offset:2048
  ds_read_b64_tr_b16 v[98:99], v17 offset:2560
  ds_read_b128 v[100:103], v18
  ds_read_b128 v[104:107], v18 offset:4096
  ds_read_b64_tr_b16 v[108:109], v15 offset:8704
  ds_read_b64_tr_b16 v[110:111], v15 offset:8832
  v_mfma_f32_32x32x16_bf16 v[32:47], v[160:163], v[164:167], v[32:47]
  v_mfma_f32_32x32x16_bf16 v[48:63], v[160:163], v[168:171], v[48:63]
  v_mfma_f32_32x32x16_bf16 v[64:79], v[172:175], v[164:167], v[64:79]
  ds_read_b64_tr_b16 v[112:113], v17 offset:4096
  ds_read_b64_tr_b16 v[114:115], v17 offset:4608
  ds_read_b128 v[116:119], v19
  ds_read_b128 v[120:123], v19 offset:4096
  ds_read_b64_tr_b16 v[124:125], v15 offset:9216
  ds_read_b64_tr_b16 v[126:127], v15 offset:9344
  v_mfma_f32_32x32x16_bf16 v[32:47], v[176:179], v[180:183], v[32:47]
  v_mfma_f32_32x32x16_bf16 v[48:63], v[176:179], v[184:187], v[48:63]
  v_mfma_f32_32x32x16_bf16 v[64:79], v[188:191], v[180:183], v[64:79]
  ds_read_b64_tr_b16 v[128:129], v17 offset:6144
  ds_read_b64_tr_b16 v[130:131], v17 offset:6656
  ds_read_b128 v[132:135], v20
  ds_read_b128 v[136:139], v20 offset:4096
  ds_read_b64_tr_b16 v[140:141], v15 offset:9728
  ds_read_b64_tr_b16 v[142:143], v15 offset:9856
  v_mfma_f32_32x32x16_bf16 v[32:47], v[192:195], v[196:199], v[32:47]
  v_mfma_f32_32x32x16_bf16 v[48:63], v[192:195], v[200:203], v[48:63]
  v_mfma_f32_32x32x16_bf16 v[64:79], v[204:207], v[196:199], v[64:79]
  s_waitcnt vmcnt(12) lgkmcnt(0)
  s_barrier
  v_add_u32 v16, 122880, v14
  v_add_u32 v17, 139264, v13
  v_xor_b32 v18, 32, v16
  v_xor_b32 v19, 64, v16
  v_xor_b32 v20, 96, v16
  ds_read_b64_tr_b16 v[144:145], v17 offset:0
  ds_read_b64_tr_b16 v[146:147], v17 offset:512
  ds_read_b128 v[148:151], v16
  ds_read_b128 v[152:155], v16 offset:4096
  ds_read_b64_tr_b16 v[156:157], v15 offset:10240
  ds_read_b64_tr_b16 v[158:159], v15 offset:10368
  v_mfma_f32_32x32x16_bf16 v[32:47], v[80:83], v[84:87], v[32:47]
  v_mfma_f32_32x32x16_bf16 v[48:63], v[80:83], v[88:91], v[48:63]
  v_mfma_f32_32x32x16_bf16 v[64:79], v[92:95], v[84:87], v[64:79]
  ds_read_b64_tr_b16 v[160:161], v17 offset:2048
  ds_read_b64_tr_b16 v[162:163], v17 offset:2560
  ds_read_b128 v[164:167], v18
  ds_read_b128 v[168:171], v18 offset:4096
  ds_read_b64_tr_b16 v[172:173], v15 offset:10752
  ds_read_b64_tr_b16 v[174:175], v15 offset:10880
  v_mfma_f32_32x32x16_bf16 v[32:47], v[96:99], v[100:103], v[32:47]
  v_mfma_f32_32x32x16_bf16 v[48:63], v[96:99], v[104:107], v[48:63]
  v_mfma_f32_32x32x16_bf16 v[64:79], v[108:111], v[100:103], v[64:79]
  ds_read_b64_tr_b16 v[176:177], v17 offset:4096
  ds_read_b64_tr_b16 v[178:179], v17 offset:4608
  ds_read_b128 v[180:183], v19
  ds_read_b128 v[184:187], v19 offset:4096
  ds_read_b64_tr_b16 v[188:189], v15 offset:11264
  ds_read_b64_tr_b16 v[190:191], v15 offset:11392
  v_mfma_f32_32x32x16_bf16 v[32:47], v[112:115], v[116:119], v[32:47]
  v_mfma_f32_32x32x16_bf16 v[48:63], v[112:115], v[120:123], v[48:63]
  v_mfma_f32_32x32x16_bf16 v[64:79], v[124:127], v[116:119], v[64:79]
  ds_read_b64_tr_b16 v[192:193], v17 offset:6144
  ds_read_b64_tr_b16 v[194:195], v17 offset:6656
  ds_read_b128 v[196:199], v20
  ds_read_b128 v[200:203], v20 offset:4096
  ds_read_b64_tr_b16 v[204:205], v15 offset:11776
  ds_read_b64_tr_b16 v[206:207], v15 offset:11904
  v_mfma_f32_32x32x16_bf16 v[32:47], v[128:131], v[132:135], v[32:47]
  v_mfma_f32_32x32x16_bf16 v[48:63], v[128:131], v[136:139], v[48:63]
  v_mfma_f32_32x32x16_bf16 v[64:79], v[140:143], v[132:135], v[64:79]
  s_waitcnt vmcnt(6) lgkmcnt(0)
  s_barrier
  v_add_u32 v16, 0, v14
  v_add_u32 v17, 16384, v13
  v_xor_b32 v18, 32, v16
  v_xor_b32 v19, 64, v16
  v_xor_b32 v20, 96, v16
  ds_read_b64_tr_b16 v[80:81], v17 offset:0
  ds_read_b64_tr_b16 v[82:83], v17 offset:512
  ds_read_b128 v[84:87], v16
  ds_read_b128 v[88:91], v16 offset:4096
  ds_read_b64_tr_b16 v[92:93], v15 offset:12288
  ds_read_b64_tr_b16 v[94:95], v15 offset:12416
  v_mfma_f32_32x32x16_bf16 v[32:47], v[144:147], v[148:151], v[32:47]
  v_mfma_f32_32x32x16_bf16 v[48:63], v[144:147], v[152:155], v[48:63]
  v_mfma_f32_32x32x16_bf16 v[64:79], v[156:159], v[148:151], v[64:79]
  ds_read_b64_tr_b16 v[96:97], v17 offset:2048
  ds_read_b64_tr_b16 v[98:99], v17 offset:2560
  ds_read_b128 v[100:103], v18
  ds_read_b128 v[104:107], v18 offset:4096
  ds_read_b64_tr_b16 v[108:109], v15 offset:12800
  ds_read_b64_tr_b16 v[110:111], v15 offset:12928
  v_mfma_f32_32x32x16_bf16 v[32:47], v[160:163], v[164:167], v[32:47]
  v_mfma_f32_32x32x16_bf16 v[48:63], v[160:163], v[168:171], v[48:63]
  v_mfma_f32_32x32x16_bf16 v[64:79], v[172:175], v[164:167], v[64:79]
  ds_read_b64_tr_b16 v[112:113], v17 offset:4096
  ds_read_b64_tr_b16 v[114:115], v17 offset:4608
  ds_read_b128 v[116:119], v19
  ds_read_b128 v[120:123], v19 offset:4096
  ds_read_b64_tr_b16 v[124:125], v15 offset:13312
  ds_read_b64_tr_b16 v[126:127], v15 offset:13440
  v_mfma_f32_32x32x16_bf16 v[32:47], v[176:179], v[180:183], v[32:47]
  v_mfma_f32_32x32x16_bf16 v[48:63], v[176:179], v[184:187], v[48:63]
  v_mfma_f32_32x32x16_bf16 v[64:79], v[188:191], v[180:183], v[64:79]
  ds_read_b64_tr_b16 v[128:129], v17 offset:6144
  ds_read_b64_tr_b16 v[130:131], v17 offset:6656
  ds_read_b128 v[132:135], v20
  ds_read_b128 v[136:139], v20 offset:4096
  ds_read_b64_tr_b16 v[140:141], v15 offset:13824
  ds_read_b64_tr_b16 v[142:143], v15 offset:13952
  v_mfma_f32_32x32x16_bf16 v[32:47], v[192:195], v[196:199], v[32:47]
  v_mfma_f32_32x32x16_bf16 v[48:63], v[192:195], v[200:203], v[48:63]
  v_mfma_f32_32x32x16_bf16 v[64:79], v[204:207], v[196:199], v[64:79]
  s_waitcnt vmcnt(0) lgkmcnt(0)
  s_barrier
  v_add_u32 v16, 24576, v14
  v_add_u32 v17, 40960, v13
  v_xor_b32 v18, 32, v16
  v_xor_b32 v19, 64, v16
  v_xor_b32 v20, 96, v16
  ds_read_b64_tr_b16 v[144:145], v17 offset:0
  ds_read_b64_tr_b16 v[146:147], v17 offset:512
  ds_read_b128 v[148:151], v16
  ds_read_b128 v[152:155], v16 offset:4096
  ds_read_b64_tr_b16 v[156:157], v15 offset:14336
  ds_read_b64_tr_b16 v[158:159], v15 offset:14464
  v_mfma_f32_32x32x16_bf16 v[32:47], v[80:83], v[84:87], v[32:47]
  v_mfma_f32_32x32x16_bf16 v[48:63], v[80:83], v[88:91], v[48:63]
  v_mfma_f32_32x32x16_bf16 v[64:79], v[92:95], v[84:87], v[64:79]
  ds_read_b64_tr_b16 v[160:161], v17 offset:2048
  ds_read_b64_tr_b16 v[162:163], v17 offset:2560
  ds_read_b128 v[164:167], v18
  ds_read_b128 v[168:171], v18 offset:4096
  ds_read_b64_tr_b16 v[172:173], v15 offset:14848
  ds_read_b64_tr_b16 v[174:175], v15 offset:14976
  v_mfma_f32_32x32x16_bf16 v[32:47], v[96:99], v[100:103], v[32:47]
  v_mfma_f32_32x32x16_bf16 v[48:63], v[96:99], v[104:107], v[48:63]
  v_mfma_f32_32x32x16_bf16 v[64:79], v[108:111], v[100:103], v[64:79]
  ds_read_b64_tr_b16 v[176:177], v17 offset:4096
  ds_read_b64_tr_b16 v[178:179], v17 offset:4608
  ds_read_b128 v[180:183], v19
  ds_read_b128 v[184:187], v19 offset:4096
  ds_read_b64_tr_b16 v[188:189], v15 offset:15360
  ds_read_b64_tr_b16 v[190:191], v15 offset:15488
  v_mfma_f32_32x32x16_bf16 v[32:47], v[112:115], v[116:119], v[32:47]
  v_mfma_f32_32x32x16_bf16 v[48:63], v[112:115], v[120:123], v[48:63]
  v_mfma_f32_32x32x16_bf16 v[64:79], v[124:127], v[116:119], v[64:79]
  ds_read_b64_tr_b16 v[192:193], v17 offset:6144
  ds_read_b64_tr_b16 v[194:195], v17 offset:6656
  ds_read_b128 v[196:199], v20
  ds_read_b128 v[200:203], v20 offset:4096
  ds_read_b64_tr_b16 v[204:205], v15 offset:15872
  ds_read_b64_tr_b16 v[206:207], v15 offset:16000
  v_mfma_f32_32x32x16_bf16 v[32:47], v[128:131], v[132:135], v[32:47]
  v_mfma_f32_32x32x16_bf16 v[48:63], v[128:131], v[136:139], v[48:63]
  v_mfma_f32_32x32x16_bf16 v[64:79], v[140:143], v[132:135], v[64:79]
  s_waitcnt lgkmcnt(15)
  v_mfma_f32_32x32x16_bf16 v[32:47], v[144:147], v[148:151], v[32:47]
  v_mfma_f32_32x32x16_bf16 v[48:63], v[144:147], v[152:155], v[48:63]
  v_mfma_f32_32x32x16_bf16 v[64:79], v[156:159], v[148:151], v[64:79]
  s_waitcnt lgkmcnt(12)
  v_mfma_f32_32x32x16_bf16 v[32:47], v[160:163], v[164:167], v[32:47]
  v_mfma_f32_32x32x16_bf16 v[48:63], v[160:163], v[168:171], v[48:63]
  v_mfma_f32_32x32x16_bf16 v[64:79], v[172:175], v[164:167], v[64:79]
  s_waitcnt lgkmcnt(6)
  v_mfma_f32_32x32x16_bf16 v[32:47], v[176:179], v[180:183], v[32:47]
  v_mfma_f32_32x32x16_bf16 v[48:63], v[176:179], v[184:187], v[48:63]
  v_mfma_f32_32x32x16_bf16 v[64:79], v[188:191], v[180:183], v[64:79]
  s_waitcnt lgkmcnt(0)
  v_mfma_f32_32x32x16_bf16 v[32:47], v[192:195], v[196:199], v[32:47]
  v_mfma_f32_32x32x16_bf16 v[48:63], v[192:195], v[200:203], v[48:63]
  v_mfma_f32_32x32x16_bf16 v[64:79], v[204:207], v[196:199], v[64:79]
  s_nop 15
  s_lshl_b32 s50, s45, 2
  s_lshr_b32 s51, s44, 1
  s_add_u32 s50, s50, s51
  s_lshl_b32 s50, s50, 10
  s_add_u32 s50, s50, 2097152
  v_cvt_pk_bf16_f32 v64, v64, v65
  v_cvt_pk_bf16_f32 v65, v66, v67
  v_cvt_pk_bf16_f32 v66, v68, v69
  v_cvt_pk_bf16_f32 v67, v70, v71
  v_lshlrev_b32 v2, 4, v0
  buffer_store_dwordx4 v[64:67], v2, s[24:27], s50 offen
  s_branch .Lk1_qepi
.Lk1_kv1:
  s_waitcnt vmcnt(12) lgkmcnt(0)
  s_barrier
  v_add_u32 v16, 0, v14
  v_add_u32 v17, 16384, v13
  v_xor_b32 v18, 32, v16
  v_xor_b32 v19, 64, v16
  v_xor_b32 v20, 96, v16
  ds_read_b64_tr_b16 v[80:81], v17 offset:0
  ds_read_b64_tr_b16 v[82:83], v17 offset:512
  ds_read_b128 v[84:87], v16
  ds_read_b128 v[88:91], v16 offset:4096
  ds_read_b64_tr_b16 v[92:93], v15 offset:0
  ds_read_b64_tr_b16 v[94:95], v15 offset:128
  s_mov_b32 s52, 384
  s_add_u32 m0, s47, 73728
  s_nop 0
  buffer_load_dwordx4 v10, s[28:31], s52 offen lds
  s_mov_b32 s52, 33152
  s_add_u32 m0, s47, 77824
  s_nop 0
  buffer_load_dwordx4 v10, s[28:31], s52 offen lds
  s_mov_b32 s52, 65920
  s_add_u32 m0, s47, 81920
  s_nop 0
  buffer_load_dwordx4 v10, s[28:31], s52 offen lds
  ds_read_b64_tr_b16 v[96:97], v17 offset:2048
  ds_read_b64_tr_b16 v[98:99], v17 offset:2560
  ds_read_b128 v[100:103], v18
  ds_read_b128 v[104:107], v18 offset:4096
  ds_read_b64_tr_b16 v[108:109], v15 offset:512
  ds_read_b64_tr_b16 v[110:111], v15 offset:640
  s_mov_b32 s52, 98688
  s_add_u32 m0, s47, 86016
  s_nop 0
  buffer_load_dwordx4 v10, s[28:31], s52 offen lds
  s_mov_b32 s52, 196608
  s_add_u32 m0, s47, 90112
  s_nop 0
  buffer_load_dwordx4 v11, s[32:35], s52 offen lds
  s_mov_b32 s52, 229376
  s_add_u32 m0, s47, 94208
  s_nop 0
  buffer_load_dwordx4 v11, s[32:35], s52 offen lds
  ds_read_b64_tr_b16 v[112:113], v17 offset:4096
  ds_read_b64_tr_b16 v[114:115], v17 offset:4608
  ds_read_b128 v[116:119], v19
  ds_read_b128 v[120:123], v19 offset:4096
  ds_read_b64_tr_b16 v[124:125], v15 offset:1024
  ds_read_b64_tr_b16 v[126:127], v15 offset:1152
  s_mov_b32 s52, 512
  s_add_u32 m0, s47, 98304
  s_nop 0
  buffer_load_dwordx4 v10, s[28:31], s52 offen lds
  s_mov_b32 s52, 33280
  s_add_u32 m0, s47, 102400
  s_nop 0
  buffer_load_dwordx4 v10, s[28:31], s52 offen lds
  s_mov_b32 s52, 66048
  s_add_u32 m0, s47, 106496
  s_nop 0
  buffer_load_dwordx4 v10, s[28:31], s52 offen lds
  ds_read_b64_tr_b16 v[128:129], v17 offset:6144
  ds_read_b64_tr_b16 v[130:131], v17 offset:6656
  ds_read_b128 v[132:135], v20
  ds_read_b128 v[136:139], v20 offset:4096
  ds_read_b64_tr_b16 v[140:141], v15 offset:1536
  ds_read_b64_tr_b16 v[142:143], v15 offset:1664
  s_mov_b32 s52, 98816
  s_add_u32 m0, s47, 110592
  s_nop 0
  buffer_load_dwordx4 v10, s[28:31], s52 offen lds
  s_mov_b32 s52, 262144
  s_add_u32 m0, s47, 114688
  s_nop 0
  buffer_load_dwordx4 v11, s[32:35], s52 offen lds
  s_mov_b32 s52, 294912
  s_add_u32 m0, s47, 118784
  s_nop 0
  buffer_load_dwordx4 v11, s[32:35], s52 offen lds
  s_waitcnt vmcnt(18) lgkmcnt(0)
  s_barrier
  v_add_u32 v16, 24576, v14
  v_add_u32 v17, 40960, v13
  v_xor_b32 v18, 32, v16
  v_xor_b32 v19, 64, v16
  v_xor_b32 v20, 96, v16
  ds_read_b64_tr_b16 v[144:145], v17 offset:0
  ds_read_b64_tr_b16 v[146:147], v17 offset:512
  ds_read_b128 v[148:151], v16
  ds_read_b128 v[152:155], v16 offset:4096
  ds_read_b64_tr_b16 v[156:157], v15 offset:2048
  ds_read_b64_tr_b16 v[158:159], v15 offset:2176
  v_mfma_f32_32x32x16_bf16 v[32:47], v[80:83], v[84:87], 0
  v_mfma_f32_32x32x16_bf16 v[48:63], v[80:83], v[88:91], 0
  v_mfma_f32_32x32x16_bf16 v[64:79], v[84:87], v[92:95], 0
  s_mov_b32 s52, 640
  s_add_u32 m0, s47, 122880
  s_nop 0
  buffer_load_dwordx4 v10, s[28:31], s52 offen lds
  s_mov_b32 s52, 33408
  s_add_u32 m0, s47, 126976
  s_nop 0
  buffer_load_dwordx4 v10, s[28:31], s52 offen lds
  s_mov_b32 s52, 66176
  s_add_u32 m0, s47, 131072
  s_nop 0
  buffer_load_dwordx4 v10, s[28:31], s52 offen lds
  ds_read_b64_tr_b16 v[160:161], v17 offset:2048
  ds_read_b64_tr_b16 v[162:163], v17 offset:2560
  ds_read_b128 v[164:167], v18
  ds_read_b128 v[168:171], v18 offset:4096
  ds_read_b64_tr_b16 v[172:173], v15 offset:2560
  ds_read_b64_tr_b16 v[174:175], v15 offset:2688
  v_mfma_f32_32x32x16_bf16 v[32:47], v[96:99], v[100:103], v[32:47]
  v_mfma_f32_32x32x16_bf16 v[48:63], v[96:99], v[104:107], v[48:63]
  v_mfma_f32_32x32x16_bf16 v[64:79], v[100:103], v[108:111], v[64:79]
  s_mov_b32 s52, 98944
  s_add_u32 m0, s47, 135168
  s_nop 0
  buffer_load_dwordx4 v10, s[28:31], s52 offen lds
  s_mov_b32 s52, 327680
  s_add_u32 m0, s47, 139264
  s_nop 0
  buffer_load_dwordx4 v11, s[32:35], s52 offen lds
  s_mov_b32 s52, 360448
  s_add_u32 m0, s47, 143360
  s_nop 0
  buffer_load_dwordx4 v11, s[32:35], s52 offen lds
  ds_read_b64_tr_b16 v[176:177], v17 offset:4096
  ds_read_b64_tr_b16 v[178:179], v17 offset:4608
  ds_read_b128 v[180:183], v19
  ds_read_b128 v[184:187], v19 offset:4096
  ds_read_b64_tr_b16 v[188:189], v15 offset:3072
  ds_read_b64_tr_b16 v[190:191], v15 offset:3200
  v_mfma_f32_32x32x16_bf16 v[32:47], v[112:115], v[116:119], v[32:47]
  v_mfma_f32_32x32x16_bf16 v[48:63], v[112:115], v[120:123], v[48:63]
  v_mfma_f32_32x32x16_bf16 v[64:79], v[116:119], v[124:127], v[64:79]
  s_mov_b32 s52, 768
  s_add_u32 m0, s47, 0
  s_nop 0
  buffer_load_dwordx4 v10, s[28:31], s52 offen lds
  s_mov_b32 s52, 33536
  s_add_u32 m0, s47, 4096
  s_nop 0
  buffer_load_dwordx4 v10, s[28:31], s52 offen lds
  s_mov_b32 s52, 66304
  s_add_u32 m0, s47, 8192
  s_nop 0
  buffer_load_dwordx4 v10, s[28:31], s52 offen lds
  ds_read_b64_tr_b16 v[192:193], v17 offset:6144
  ds_read_b64_tr_b16 v[194:195], v17 offset:6656
  ds_read_b128 v[196:199], v20
  ds_read_b128 v[200:203], v20 offset:4096
  ds_read_b64_tr_b16 v[204:205], v15 offset:3584
  ds_read_b64_tr_b16 v[206:207], v15 offset:3712
  v_mfma_f32_32x32x16_bf16 v[32:47], v[128:131], v[132:135], v[32:47]
  v_mfma_f32_32x32x16_bf16 v[48:63], v[128:131], v[136:139], v[48:63]
  v_mfma_f32_32x32x16_bf16 v[64:79], v[132:135], v[140:143], v[64:79]
  s_mov_b32 s52, 99072
  s_add_u32 m0, s47, 12288
  s_nop 0
  buffer_load_dwordx4 v10, s[28:31], s52 offen lds
  s_mov_b32 s52, 393216
  s_add_u32 m0, s47, 16384
  s_nop 0
  buffer_load_dwordx4 v11, s[32:35], s52 offen lds
  s_mov_b32 s52, 425984
  s_add_u32 m0, s47, 20480
  s_nop 0
  buffer_load_dwordx4 v11, s[32:35], s52 offen lds
  s_waitcnt vmcnt(24) lgkmcnt(0)
  s_barrier
  v_add_u32 v16, 49152, v14
  v_add_u32 v17, 65536, v13
  v_xor_b32 v18, 32, v16
  v_xor_b32 v19, 64, v16
  v_xor_b32 v20, 96, v16
  ds_read_b64_tr_b16 v[80:81], v17 offset:0
  ds_read_b64_tr_b16 v[82:83], v17 offset:512
  ds_read_b128 v[84:87], v16
  ds_read_b128 v[88:91], v16 offset:4096
  ds_read_b64_tr_b16 v[92:93], v15 offset:4096
  ds_read_b64_tr_b16 v[94:95], v15 offset:4224
  v_mfma_f32_32x32x16_bf16 v[32:47], v[144:147], v[148:151], v[32:47]
  v_mfma_f32_32x32x16_bf16 v[48:63], v[144:147], v[152:155], v[48:63]
  v_mfma_f32_32x32x16_bf16 v[64:79], v[148:151], v[156:159], v[64:79]
  s_mov_b32 s52, 896
  s_add_u32 m0, s47, 24576
  s_nop 0
  buffer_load_dwordx4 v10, s[28:31], s52 offen lds
  s_mov_b32 s52, 33664
  s_add_u32 m0, s47, 28672
  s_nop 0
  buffer_load_dwordx4 v10, s[28:31], s52 offen lds
  ds_read_b64_tr_b16 v[96:97], v17 offset:2048
  ds_read_b64_tr_b16 v[98:99], v17 offset:2560
  ds_read_b128 v[100:103], v18
  ds_read_b128 v[104:107], v18 offset:4096
  ds_read_b64_tr_b16 v[108:109], v15 offset:4608
  ds_read_b64_tr_b16 v[110:111], v15 offset:4736
  v_mfma_f32_32x32x16_bf16 v[32:47], v[160:163], v[164:167], v[32:47]
  v_mfma_f32_32x32x16_bf16 v[48:63], v[160:163], v[168:171], v[48:63]
  v_mfma_f32_32x32x16_bf16 v[64:79], v[164:167], v[172:175], v[64:79]
  s_mov_b32 s52, 66432
  s_add_u32 m0, s47, 32768
  s_nop 0
  buffer_load_dwordx4 v10, s[28:31], s52 offen lds
  s_mov_b32 s52, 99200
  s_add_u32 m0, s47, 36864
  s_nop 0
  buffer_load_dwordx4 v10, s[28:31], s52 offen lds
  ds_read_b64_tr_b16 v[112:113], v17 offset:4096
  ds_read_b64_tr_b16 v[114:115], v17 offset:4608
  ds_read_b128 v[116:119], v19
  ds_read_b128 v[120:123], v19 offset:4096
  ds_read_b64_tr_b16 v[124:125], v15 offset:5120
  ds_read_b64_tr_b16 v[126:127], v15 offset:5248
  v_mfma_f32_32x32x16_bf16 v[32:47], v[176:179], v[180:183], v[32:47]
  v_mfma_f32_32x32x16_bf16 v[48:63], v[176:179], v[184:187], v[48:63]
  v_mfma_f32_32x32x16_bf16 v[64:79], v[180:183], v[188:191], v[64:79]
  s_mov_b32 s52, 458752
  s_add_u32 m0, s47, 40960
  s_nop 0
  buffer_load_dwordx4 v11, s[32:35], s52 offen lds
  s_mov_b32 s52, 491520
  s_add_u32 m0, s47, 45056
  s_nop 0
  buffer_load_dwordx4 v11, s[32:35], s52 offen lds
  ds_read_b64_tr_b16 v[128:129], v17 offset:6144
  ds_read_b64_tr_b16 v[130:131], v17 offset:6656
  ds_read_b128 v[132:135], v20
  ds_read_b128 v[136:139], v20 offset:4096
  ds_read_b64_tr_b16 v[140:141], v15 offset:5632
  ds_read_b64_tr_b16 v[142:143], v15 offset:5760
  v_mfma_f32_32x32x16_bf16 v[32:47], v[192:195], v[196:199], v[32:47]
  v_mfma_f32_32x32x16_bf16 v[48:63], v[192:195], v[200:203], v[48:63]
  v_mfma_f32_32x32x16_bf16 v[64:79], v[196:199], v[204:207], v[64:79]
  s_waitcnt vmcnt(24) lgkmcnt(0)
  s_barrier
  v_add_u32 v16, 73728, v14
  v_add_u32 v17, 90112, v13
  v_xor_b32 v18, 32, v16
  v_xor_b32 v19, 64, v16
  v_xor_b32 v20, 96, v16
  ds_read_b64_tr_b16 v[144:145], v17 offset:0
  ds_read_b64_tr_b16 v[146:147], v17 offset:512
  ds_read_b128 v[148:151], v16
  ds_read_b128 v[152:155], v16 offset:4096
  ds_read_b64_tr_b16 v[156:157], v15 offset:6144
  ds_read_b64_tr_b16 v[158:159], v15 offset:6272
  v_mfma_f32_32x32x16_bf16 v[32:47], v[80:83], v[84:87], v[32:47]
  v_mfma_f32_32x32x16_bf16 v[48:63], v[80:83], v[88:91], v[48:63]
  v_mfma_f32_32x32x16_bf16 v[64:79], v[84:87], v[92:95], v[64:79]
  ds_read_b64_tr_b16 v[160:161], v17 offset:2048
  ds_read_b64_tr_b16 v[162:163], v17 offset:2560
  ds_read_b128 v[164:167], v18
  ds_read_b128 v[168:171], v18 offset:4096
  ds_read_b64_tr_b16 v[172:173], v15 offset:6656
  ds_read_b64_tr_b16 v[174:175], v15 offset:6784
  v_mfma_f32_32x32x16_bf16 v[32:47], v[96:99], v[100:103], v[32:47]
  v_mfma_f32_32x32x16_bf16 v[48:63], v[96:99], v[104:107], v[48:63]
  v_mfma_f32_32x32x16_bf16 v[64:79], v[100:103], v[108:111], v[64:79]
  ds_read_b64_tr_b16 v[176:177], v17 offset:4096
  ds_read_b64_tr_b16 v[178:179], v17 offset:4608
  ds_read_b128 v[180:183], v19
  ds_read_b128 v[184:187], v19 offset:4096
  ds_read_b64_tr_b16 v[188:189], v15 offset:7168
  ds_read_b64_tr_b16 v[190:191], v15 offset:7296
  v_mfma_f32_32x32x16_bf16 v[32:47], v[112:115], v[116:119], v[32:47]
  v_mfma_f32_32x32x16_bf16 v[48:63], v[112:115], v[120:123], v[48:63]
  v_mfma_f32_32x32x16_bf16 v[64:79], v[116:119], v[124:127], v[64:79]
  ds_read_b64_tr_b16 v[192:193], v17 offset:6144
  ds_read_b64_tr_b16 v[194:195], v17 offset:6656
  ds_read_b128 v[196:199], v20
  ds_read_b128 v[200:203], v20 offset:4096
  ds_read_b64_tr_b16 v[204:205], v15 offset:7680
  ds_read_b64_tr_b16 v[206:207], v15 offset:7808
  v_mfma_f32_32x32x16_bf16 v[32:47], v[128:131], v[132:135], v[32:47]
  v_mfma_f32_32x32x16_bf16 v[48:63], v[128:131], v[136:139], v[48:63]
  v_mfma_f32_32x32x16_bf16 v[64:79], v[132:135], v[140:143], v[64:79]
  s_waitcnt vmcnt(18) lgkmcnt(0)
  s_barrier
  v_add_u32 v16, 98304, v14
  v_add_u32 v17, 114688, v13
  v_xor_b32 v18, 32, v16
  v_xor_b32 v19, 64, v16
  v_xor_b32 v20, 96, v16
  ds_read_b64_tr_b16 v[80:81], v17 offset:0
  ds_read_b64_tr_b16 v[82:83], v17 offset:512
  ds_read_b128 v[84:87], v16
  ds_read_b128 v[88:91], v16 offset:4096
  ds_read_b64_tr_b16 v[92:93], v15 offset:8192
  ds_read_b64_tr_b16 v[94:95], v15 offset:8320
  v_mfma_f32_32x32x16_bf16 v[32:47], v[144:147], v[148:151], v[32:47]
  v_mfma_f32_32x32x16_bf16 v[48:63], v[144:147], v[152:155], v[48:63]
  v_mfma_f32_32x32x16_bf16 v[64:79], v[148:151], v[156:159], v[64:79]
  ds_read_b64_tr_b16 v[96:97], v17 offset:2048
  ds_read_b64_tr_b16 v[98:99], v17 offset:2560
  ds_read_b128 v[100:103], v18
  ds_read_b128 v[104:107], v18 offset:4096
  ds_read_b64_tr_b16 v[108:109], v15 offset:8704
  ds_read_b64_tr_b16 v[110:111], v15 offset:8832
  v_mfma_f32_32x32x16_bf16 v[32:47], v[160:163], v[164:167], v[32:47]
  v_mfma_f32_32x32x16_bf16 v[48:63], v[160:163], v[168:171], v[48:63]
  v_mfma_f32_32x32x16_bf16 v[64:79], v[164:167], v[172:175], v[64:79]
  ds_read_b64_tr_b16 v[112:113], v17 offset:4096
  ds_read_b64_tr_b16 v[114:115], v17 offset:4608
  ds_read_b128 v[116:119], v19
  ds_read_b128 v[120:123], v19 offset:4096
  ds_read_b64_tr_b16 v[124:125], v15 offset:9216
  ds_read_b64_tr_b16 v[126:127], v15 offset:9344
  v_mfma_f32_32x32x16_bf16 v[32:47], v[176:179], v[180:183], v[32:47]
  v_mfma_f32_32x32x16_bf16 v[48:63], v[176:179], v[184:187], v[48:63]
  v_mfma_f32_32x32x16_bf16 v[64:79], v[180:183], v[188:191], v[64:79]
  ds_read_b64_tr_b16 v[128:129], v17 offset:6144
  ds_read_b64_tr_b16 v[130:131], v17 offset:6656
  ds_read_b128 v[132:135], v20
  ds_read_b128 v[136:139], v20 offset:4096
  ds_read_b64_tr_b16 v[140:141], v15 offset:9728
  ds_read_b64_tr_b16 v[142:143], v15 offset:9856
  v_mfma_f32_32x32x16_bf16 v[32:47], v[192:195], v[196:199], v[32:47]
  v_mfma_f32_32x32x16_bf16 v[48:63], v[192:195], v[200:203], v[48:63]
  v_mfma_f32_32x32x16_bf16 v[64:79], v[196:199], v[204:207], v[64:79]
  s_waitcnt vmcnt(12) lgkmcnt(0)
  s_barrier
  v_add_u32 v16, 122880, v14
  v_add_u32 v17, 139264, v13
  v_xor_b32 v18, 32, v16
  v_xor_b32 v19, 64, v16
  v_xor_b32 v20, 96, v16
  ds_read_b64_tr_b16 v[144:145], v17 offset:0
  ds_read_b64_tr_b16 v[146:147], v17 offset:512
  ds_read_b128 v[148:151], v16
  ds_read_b128 v[152:155], v16 offset:4096
  ds_read_b64_tr_b16 v[156:157], v15 offset:10240
  ds_read_b64_tr_b16 v[158:159], v15 offset:10368
  v_mfma_f32_32x32x16_bf16 v[32:47], v[80:83], v[84:87], v[32:47]
  v_mfma_f32_32x32x16_bf16 v[48:63], v[80:83], v[88:91], v[48:63]
  v_mfma_f32_32x32x16_bf16 v[64:79], v[84:87], v[92:95], v[64:79]
  ds_read_b64_tr_b16 v[160:161], v17 offset:2048
  ds_read_b64_tr_b16 v[162:163], v17 offset:2560
  ds_read_b128 v[164:167], v18
  ds_read_b128 v[168:171], v18 offset:4096
  ds_read_b64_tr_b16 v[172:173], v15 offset:10752
  ds_read_b64_tr_b16 v[174:175], v15 offset:10880
  v_mfma_f32_32x32x16_bf16 v[32:47], v[96:99], v[100:103], v[32:47]
  v_mfma_f32_32x32x16_bf16 v[48:63], v[96:99], v[104:107], v[48:63]
  v_mfma_f32_32x32x16_bf16 v[64:79], v[100:103], v[108:111], v[64:79]
  ds_read_b64_tr_b16 v[176:177], v17 offset:4096
  ds_read_b64_tr_b16 v[178:179], v17 offset:4608
  ds_read_b128 v[180:183], v19
  ds_read_b128 v[184:187], v19 offset:4096
  ds_read_b64_tr_b16 v[188:189], v15 offset:11264
  ds_read_b64_tr_b16 v[190:191], v15 offset:11392
  v_mfma_f32_32x32x16_bf16 v[32:47], v[112:115], v[116:119], v[32:47]
  v_mfma_f32_32x32x16_bf16 v[48:63], v[112:115], v[120:123], v[48:63]
  v_mfma_f32_32x32x16_bf16 v[64:79], v[116:119], v[124:127], v[64:79]
  ds_read_b64_tr_b16 v[192:193], v17 offset:6144
  ds_read_b64_tr_b16 v[194:195], v17 offset:6656
  ds_read_b128 v[196:199], v20
  ds_read_b128 v[200:203], v20 offset:4096
  ds_read_b64_tr_b16 v[204:205], v15 offset:11776
  ds_read_b64_tr_b16 v[206:207], v15 offset:11904
  v_mfma_f32_32x32x16_bf16 v[32:47], v[128:131], v[132:135], v[32:47]
  v_mfma_f32_32x32x16_bf16 v[48:63], v[128:131], v[136:139], v[48:63]
  v_mfma_f32_32x32x16_bf16 v[64:79], v[132:135], v[140:143], v[64:79]
  s_waitcnt vmcnt(6) lgkmcnt(0)
  s_barrier
  v_add_u32 v16, 0, v14
  v_add_u32 v17, 16384, v13
  v_xor_b32 v18, 32, v16
  v_xor_b32 v19, 64, v16
  v_xor_b32 v20, 96, v16
  ds_read_b64_tr_b16 v[80:81], v17 offset:0
  ds_read_b64_tr_b16 v[82:83], v17 offset:512
  ds_read_b128 v[84:87], v16
  ds_read_b128 v[88:91], v16 offset:4096
  ds_read_b64_tr_b16 v[92:93], v15 offset:12288
  ds_read_b64_tr_b16 v[94:95], v15 offset:12416
  v_mfma_f32_32x32x16_bf16 v[32:47], v[144:147], v[148:151], v[32:47]
  v_mfma_f32_32x32x16_bf16 v[48:63], v[144:147], v[152:155], v[48:63]
  v_mfma_f32_32x32x16_bf16 v[64:79], v[148:151], v[156:159], v[64:79]
  ds_read_b64_tr_b16 v[96:97], v17 offset:2048
  ds_read_b64_tr_b16 v[98:99], v17 offset:2560
  ds_read_b128 v[100:103], v18
  ds_read_b128 v[104:107], v18 offset:4096
  ds_read_b64_tr_b16 v[108:109], v15 offset:12800
  ds_read_b64_tr_b16 v[110:111], v15 offset:12928
  v_mfma_f32_32x32x16_bf16 v[32:47], v[160:163], v[164:167], v[32:47]
  v_mfma_f32_32x32x16_bf16 v[48:63], v[160:163], v[168:171], v[48:63]
  v_mfma_f32_32x32x16_bf16 v[64:79], v[164:167], v[172:175], v[64:79]
  ds_read_b64_tr_b16 v[112:113], v17 offset:4096
  ds_read_b64_tr_b16 v[114:115], v17 offset:4608
  ds_read_b128 v[116:119], v19
  ds_read_b128 v[120:123], v19 offset:4096
  ds_read_b64_tr_b16 v[124:125], v15 offset:13312
  ds_read_b64_tr_b16 v[126:127], v15 offset:13440
  v_mfma_f32_32x32x16_bf16 v[32:47], v[176:179], v[180:183], v[32:47]
  v_mfma_f32_32x32x16_bf16 v[48:63], v[176:179], v[184:187], v[48:63]
  v_mfma_f32_32x32x16_bf16 v[64:79], v[180:183], v[188:191], v[64:79]
  ds_read_b64_tr_b16 v[128:129], v17 offset:6144
  ds_read_b64_tr_b16 v[130:131], v17 offset:6656
  ds_read_b128 v[132:135], v20
  ds_read_b128 v[136:139], v20 offset:4096
  ds_read_b64_tr_b16 v[140:141], v15 offset:13824
  ds_read_b64_tr_b16 v[142:143], v15 offset:13952
  v_mfma_f32_32x32x16_bf16 v[32:47], v[192:195], v[196:199], v[32:47]
  v_mfma_f32_32x32x16_bf16 v[48:63], v[192:195], v[200:203], v[48:63]
  v_mfma_f32_32x32x16_bf16 v[64:79], v[196:199], v[204:207], v[64:79]
  s_waitcnt vmcnt(0) lgkmcnt(0)
  s_barrier
  v_add_u32 v16, 24576, v14
  v_add_u32 v17, 40960, v13
  v_xor_b32 v18, 32, v16
  v_xor_b32 v19, 64, v16
  v_xor_b32 v20, 96, v16
  ds_read_b64_tr_b16 v[144:145], v17 offset:0
  ds_read_b64_tr_b16 v[146:147], v17 offset:512
  ds_read_b128 v[148:151], v16
  ds_read_b128 v[152:155], v16 offset:4096
  ds_read_b64_tr_b16 v[156:157], v15 offset:14336
  ds_read_b64_tr_b16 v[158:159], v15 offset:14464
  v_mfma_f32_32x32x16_bf16 v[32:47], v[80:83], v[84:87], v[32:47]
  v_mfma_f32_32x32x16_bf16 v[48:63], v[80:83], v[88:91], v[48:63]
  v_mfma_f32_32x32x16_bf16 v[64:79], v[84:87], v[92:95], v[64:79]
  ds_read_b64_tr_b16 v[160:161], v17 offset:2048
  ds_read_b64_tr_b16 v[162:163], v17 offset:2560
  ds_read_b128 v[164:167], v18
  ds_read_b128 v[168:171], v18 offset:4096
  ds_read_b64_tr_b16 v[172:173], v15 offset:14848
  ds_read_b64_tr_b16 v[174:175], v15 offset:14976
  v_mfma_f32_32x32x16_bf16 v[32:47], v[96:99], v[100:103], v[32:47]
  v_mfma_f32_32x32x16_bf16 v[48:63], v[96:99], v[104:107], v[48:63]
  v_mfma_f32_32x32x16_bf16 v[64:79], v[100:103], v[108:111], v[64:79]
  ds_read_b64_tr_b16 v[176:177], v17 offset:4096
  ds_read_b64_tr_b16 v[178:179], v17 offset:4608
  ds_read_b128 v[180:183], v19
  ds_read_b128 v[184:187], v19 offset:4096
  ds_read_b64_tr_b16 v[188:189], v15 offset:15360
  ds_read_b64_tr_b16 v[190:191], v15 offset:15488
  v_mfma_f32_32x32x16_bf16 v[32:47], v[112:115], v[116:119], v[32:47]
  v_mfma_f32_32x32x16_bf16 v[48:63], v[112:115], v[120:123], v[48:63]
  v_mfma_f32_32x32x16_bf16 v[64:79], v[116:119], v[124:127], v[64:79]
  ds_read_b64_tr_b16 v[192:193], v17 offset:6144
  ds_read_b64_tr_b16 v[194:195], v17 offset:6656
  ds_read_b128 v[196:199], v20
  ds_read_b128 v[200:203], v20 offset:4096
  ds_read_b64_tr_b16 v[204:205], v15 offset:15872
  ds_read_b64_tr_b16 v[206:207], v15 offset:16000
  v_mfma_f32_32x32x16_bf16 v[32:47], v[128:131], v[132:135], v[32:47]
  v_mfma_f32_32x32x16_bf16 v[48:63], v[128:131], v[136:139], v[48:63]
  v_mfma_f32_32x32x16_bf16 v[64:79], v[132:135], v[140:143], v[64:79]
  s_waitcnt lgkmcnt(15)
  v_mfma_f32_32x32x16_bf16 v[32:47], v[144:147], v[148:151], v[32:47]
  v_mfma_f32_32x32x16_bf16 v[48:63], v[144:147], v[152:155], v[48:63]
  v_mfma_f32_32x32x16_bf16 v[64:79], v[148:151], v[156:159], v[64:79]
  s_waitcnt lgkmcnt(12)
  v_mfma_f32_32x32x16_bf16 v[32:47], v[160:163], v[164:167], v[32:47]
  v_mfma_f32_32x32x16_bf16 v[48:63], v[160:163], v[168:171], v[48:63]
  v_mfma_f32_32x32x16_bf16 v[64:79], v[164:167], v[172:175], v[64:79]
  s_waitcnt lgkmcnt(6)
  v_mfma_f32_32x32x16_bf16 v[32:47], v[176:179], v[180:183], v[32:47]
  v_mfma_f32_32x32x16_bf16 v[48:63], v[176:179], v[184:187], v[48:63]
  v_mfma_f32_32x32x16_bf16 v[64:79], v[180:183], v[188:191], v[64:79]
  s_waitcnt lgkmcnt(0)
  v_mfma_f32_32x32x16_bf16 v[32:47], v[192:195], v[196:199], v[32:47]
  v_mfma_f32_32x32x16_bf16 v[48:63], v[192:195], v[200:203], v[48:63]
  v_mfma_f32_32x32x16_bf16 v[64:79], v[196:199], v[204:207], v[64:79]
  s_nop 15
  s_lshl_b32 s50, s45, 2
  s_lshr_b32 s51, s44, 1
  s_add_u32 s50, s50, s51
  s_lshl_b32 s50, s50, 10
  s_add_u32 s50, s50, 2162688
  v_cvt_pk_bf16_f32 v64, v64, v65
  v_cvt_pk_bf16_f32 v65, v66, v67
  v_cvt_pk_bf16_f32 v66, v68, v69
  v_cvt_pk_bf16_f32 v67, v70, v71
  v_cvt_pk_bf16_f32 v68, v72, v73
  v_cvt_pk_bf16_f32 v69, v74, v75
  v_cvt_pk_bf16_f32 v70, v76, v77
  v_cvt_pk_bf16_f32 v71, v78, v79
  v_bfe_u32 v2, v0, 4, 1
  v_cmp_eq_u32 vcc, 1, v2
  v_lshlrev_b32 v2, 9, v2
  v_lshrrev_b32 v3, 5, v0
  v_lshl_add_u32 v2, v3, 8, v2
  v_and_b32 v3, 15, v0
  v_lshl_add_u32 v2, v3, 4, v2
  v_cndmask_b32 v64, v64, v68, vcc
  v_cndmask_b32 v65, v65, v69, vcc
  v_cndmask_b32 v66, v66, v70, vcc
  v_cndmask_b32 v67, v67, v71, vcc
  buffer_store_dwordx4 v[64:67], v2, s[24:27], s50 offen
  s_branch .Lk1_qepi
.Lk1_kv2:
  s_waitcnt vmcnt(12) lgkmcnt(0)
  s_barrier
  v_add_u32 v16, 0, v14
  v_add_u32 v17, 16384, v13
  v_xor_b32 v18, 32, v16
  v_xor_b32 v19, 64, v16
  v_xor_b32 v20, 96, v16
  ds_read_b64_tr_b16 v[80:81], v17 offset:0
  ds_read_b64_tr_b16 v[82:83], v17 offset:512
  ds_read_b128 v[84:87], v16
  ds_read_b128 v[88:91], v16 offset:4096
  ds_read_b64_tr_b16 v[92:93], v15 offset:0
  ds_read_b64_tr_b16 v[94:95], v15 offset:128
  s_mov_b32 s52, 384
  s_add_u32 m0, s47, 73728
  s_nop 0
  buffer_load_dwordx4 v10, s[28:31], s52 offen lds
  s_mov_b32 s52, 33152
  s_add_u32 m0, s47, 77824
  s_nop 0
  buffer_load_dwordx4 v10, s[28:31], s52 offen lds
  s_mov_b32 s52, 65920
  s_add_u32 m0, s47, 81920
  s_nop 0
  buffer_load_dwordx4 v10, s[28:31], s52 offen lds
  ds_read_b64_tr_b16 v[96:97], v17 offset:2048
  ds_read_b64_tr_b16 v[98:99], v17 offset:2560
  ds_read_b128 v[100:103], v18
  ds_read_b128 v[104:107], v18 offset:4096
  ds_read_b64_tr_b16 v[108:109], v15 offset:512
  ds_read_b64_tr_b16 v[110:111], v15 offset:640
  s_mov_b32 s52, 98688
  s_add_u32 m0, s47, 86016
  s_nop 0
  buffer_load_dwordx4 v10, s[28:31], s52 offen lds
  s_mov_b32 s52, 196608
  s_add_u32 m0, s47, 90112
  s_nop 0
  buffer_load_dwordx4 v11, s[32:35], s52 offen lds
  s_mov_b32 s52, 229376
  s_add_u32 m0, s47, 94208
  s_nop 0
  buffer_load_dwordx4 v11, s[32:35], s52 offen lds
  ds_read_b64_tr_b16 v[112:113], v17 offset:4096
  ds_read_b64_tr_b16 v[114:115], v17 offset:4608
  ds_read_b128 v[116:119], v19
  ds_read_b128 v[120:123], v19 offset:4096
  ds_read_b64_tr_b16 v[124:125], v15 offset:1024
  ds_read_b64_tr_b16 v[126:127], v15 offset:1152
  s_mov_b32 s52, 512
  s_add_u32 m0, s47, 98304
  s_nop 0
  buffer_load_dwordx4 v10, s[28:31], s52 offen lds
  s_mov_b32 s52, 33280
  s_add_u32 m0, s47, 102400
  s_nop 0
  buffer_load_dwordx4 v10, s[28:31], s52 offen lds
  s_mov_b32 s52, 66048
  s_add_u32 m0, s47, 106496
  s_nop 0
  buffer_load_dwordx4 v10, s[28:31], s52 offen lds
  ds_read_b64_tr_b16 v[128:129], v17 offset:6144
  ds_read_b64_tr_b16 v[130:131], v17 offset:6656
  ds_read_b128 v[132:135], v20
  ds_read_b128 v[136:139], v20 offset:4096
  ds_read_b64_tr_b16 v[140:141], v15 offset:1536
  ds_read_b64_tr_b16 v[142:143], v15 offset:1664
  s_mov_b32 s52, 98816
  s_add_u32 m0, s47, 110592
  s_nop 0
  buffer_load_dwordx4 v10, s[28:31], s52 offen lds
  s_mov_b32 s52, 262144
  s_add_u32 m0, s47, 114688
  s_nop 0
  buffer_load_dwordx4 v11, s[32:35], s52 offen lds
  s_mov_b32 s52, 294912
  s_add_u32 m0, s47, 118784
  s_nop 0
  buffer_load_dwordx4 v11, s[32:35], s52 offen lds
  s_waitcnt vmcnt(18) lgkmcnt(0)
  s_barrier
  v_add_u32 v16, 24576, v14
  v_add_u32 v17, 40960, v13
  v_xor_b32 v18, 32, v16
  v_xor_b32 v19, 64, v16
  v_xor_b32 v20, 96, v16
  ds_read_b64_tr_b16 v[144:145], v17 offset:0
  ds_read_b64_tr_b16 v[146:147], v17 offset:512
  ds_read_b128 v[148:151], v16
  ds_read_b128 v[152:155], v16 offset:4096
  ds_read_b64_tr_b16 v[156:157], v15 offset:2048
  ds_read_b64_tr_b16 v[158:159], v15 offset:2176
  v_mfma_f32_32x32x16_bf16 v[32:47], v[80:83], v[84:87], 0
  v_mfma_f32_32x32x16_bf16 v[48:63], v[80:83], v[88:91], 0
  v_mfma_f32_32x32x16_bf16 v[64:79], v[92:95], v[88:91], 0
  s_mov_b32 s52, 640
  s_add_u32 m0, s47, 122880
  s_nop 0
  buffer_load_dwordx4 v10, s[28:31], s52 offen lds
  s_mov_b32 s52, 33408
  s_add_u32 m0, s47, 126976
  s_nop 0
  buffer_load_dwordx4 v10, s[28:31], s52 offen lds
  s_mov_b32 s52, 66176
  s_add_u32 m0, s47, 131072
  s_nop 0
  buffer_load_dwordx4 v10, s[28:31], s52 offen lds
  ds_read_b64_tr_b16 v[160:161], v17 offset:2048
  ds_read_b64_tr_b16 v[162:163], v17 offset:2560
  ds_read_b128 v[164:167], v18
  ds_read_b128 v[168:171], v18 offset:4096
  ds_read_b64_tr_b16 v[172:173], v15 offset:2560
  ds_read_b64_tr_b16 v[174:175], v15 offset:2688
  v_mfma_f32_32x32x16_bf16 v[32:47], v[96:99], v[100:103], v[32:47]
  v_mfma_f32_32x32x16_bf16 v[48:63], v[96:99], v[104:107], v[48:63]
  v_mfma_f32_32x32x16_bf16 v[64:79], v[108:111], v[104:107], v[64:79]
  s_mov_b32 s52, 98944
  s_add_u32 m0, s47, 135168
  s_nop 0
  buffer_load_dwordx4 v10, s[28:31], s52 offen lds
  s_mov_b32 s52, 327680
  s_add_u32 m0, s47, 139264
  s_nop 0
  buffer_load_dwordx4 v11, s[32:35], s52 offen lds
  s_mov_b32 s52, 360448
  s_add_u32 m0, s47, 143360
  s_nop 0
  buffer_load_dwordx4 v11, s[32:35], s52 offen lds
  ds_read_b64_tr_b16 v[176:177], v17 offset:4096
  ds_read_b64_tr_b16 v[178:179], v17 offset:4608
  ds_read_b128 v[180:183], v19
  ds_read_b128 v[184:187], v19 offset:4096
  ds_read_b64_tr_b16 v[188:189], v15 offset:3072
  ds_read_b64_tr_b16 v[190:191], v15 offset:3200
  v_mfma_f32_32x32x16_bf16 v[32:47], v[112:115], v[116:119], v[32:47]
  v_mfma_f32_32x32x16_bf16 v[48:63], v[112:115], v[120:123], v[48:63]
  v_mfma_f32_32x32x16_bf16 v[64:79], v[124:127], v[120:123], v[64:79]
  s_mov_b32 s52, 768
  s_add_u32 m0, s47, 0
  s_nop 0
  buffer_load_dwordx4 v10, s[28:31], s52 offen lds
  s_mov_b32 s52, 33536
  s_add_u32 m0, s47, 4096
  s_nop 0
  buffer_load_dwordx4 v10, s[28:31], s52 offen lds
  s_mov_b32 s52, 66304
  s_add_u32 m0, s47, 8192
  s_nop 0
  buffer_load_dwordx4 v10, s[28:31], s52 offen lds
  ds_read_b64_tr_b16 v[192:193], v17 offset:6144
  ds_read_b64_tr_b16 v[194:195], v17 offset:6656
  ds_read_b128 v[196:199], v20
  ds_read_b128 v[200:203], v20 offset:4096
  ds_read_b64_tr_b16 v[204:205], v15 offset:3584
  ds_read_b64_tr_b16 v[206:207], v15 offset:3712
  v_mfma_f32_32x32x16_bf16 v[32:47], v[128:131], v[132:135], v[32:47]
  v_mfma_f32_32x32x16_bf16 v[48:63], v[128:131], v[136:139], v[48:63]
  v_mfma_f32_32x32x16_bf16 v[64:79], v[140:143], v[136:139], v[64:79]
  s_mov_b32 s52, 99072
  s_add_u32 m0, s47, 12288
  s_nop 0
  buffer_load_dwordx4 v10, s[28:31], s52 offen lds
  s_mov_b32 s52, 393216
  s_add_u32 m0, s47, 16384
  s_nop 0
  buffer_load_dwordx4 v11, s[32:35], s52 offen lds
  s_mov_b32 s52, 425984
  s_add_u32 m0, s47, 20480
  s_nop 0
  buffer_load_dwordx4 v11, s[32:35], s52 offen lds
  s_waitcnt vmcnt(24) lgkmcnt(0)
  s_barrier
  v_add_u32 v16, 49152, v14
  v_add_u32 v17, 65536, v13
  v_xor_b32 v18, 32, v16
  v_xor_b32 v19, 64, v16
  v_xor_b32 v20, 96, v16
  ds_read_b64_tr_b16 v[80:81], v17 offset:0
  ds_read_b64_tr_b16 v[82:83], v17 offset:512
  ds_read_b128 v[84:87], v16
  ds_read_b128 v[88:91], v16 offset:4096
  ds_read_b64_tr_b16 v[92:93], v15 offset:4096
  ds_read_b64_tr_b16 v[94:95], v15 offset:4224
  v_mfma_f32_32x32x16_bf16 v[32:47], v[144:147], v[148:151], v[32:47]
  v_mfma_f32_32x32x16_bf16 v[48:63], v[144:147], v[152:155], v[48:63]
  v_mfma_f32_32x32x16_bf16 v[64:79], v[156:159], v[152:155], v[64:79]
  s_mov_b32 s52, 896
  s_add_u32 m0, s47, 24576
  s_nop 0
  buffer_load_dwordx4 v10, s[28:31], s52 offen lds
  s_mov_b32 s52, 33664
  s_add_u32 m0, s47, 28672
  s_nop 0
  buffer_load_dwordx4 v10, s[28:31], s52 offen lds
  ds_read_b64_tr_b16 v[96:97], v17 offset:2048
  ds_read_b64_tr_b16 v[98:99], v17 offset:2560
  ds_read_b128 v[100:103], v18
  ds_read_b128 v[104:107], v18 offset:4096
  ds_read_b64_tr_b16 v[108:109], v15 offset:4608
  ds_read_b64_tr_b16 v[110:111], v15 offset:4736
  v_mfma_f32_32x32x16_bf16 v[32:47], v[160:163], v[164:167], v[32:47]
  v_mfma_f32_32x32x16_bf16 v[48:63], v[160:163], v[168:171], v[48:63]
  v_mfma_f32_32x32x16_bf16 v[64:79], v[172:175], v[168:171], v[64:79]
  s_mov_b32 s52, 66432
  s_add_u32 m0, s47, 32768
  s_nop 0
  buffer_load_dwordx4 v10, s[28:31], s52 offen lds
  s_mov_b32 s52, 99200
  s_add_u32 m0, s47, 36864
  s_nop 0
  buffer_load_dwordx4 v10, s[28:31], s52 offen lds
  ds_read_b64_tr_b16 v[112:113], v17 offset:4096
  ds_read_b64_tr_b16 v[114:115], v17 offset:4608
  ds_read_b128 v[116:119], v19
  ds_read_b128 v[120:123], v19 offset:4096
  ds_read_b64_tr_b16 v[124:125], v15 offset:5120
  ds_read_b64_tr_b16 v[126:127], v15 offset:5248
  v_mfma_f32_32x32x16_bf16 v[32:47], v[176:179], v[180:183], v[32:47]
  v_mfma_f32_32x32x16_bf16 v[48:63], v[176:179], v[184:187], v[48:63]
  v_mfma_f32_32x32x16_bf16 v[64:79], v[188:191], v[184:187], v[64:79]
  s_mov_b32 s52, 458752
  s_add_u32 m0, s47, 40960
  s_nop 0
  buffer_load_dwordx4 v11, s[32:35], s52 offen lds
  s_mov_b32 s52, 491520
  s_add_u32 m0, s47, 45056
  s_nop 0
  buffer_load_dwordx4 v11, s[32:35], s52 offen lds
  ds_read_b64_tr_b16 v[128:129], v17 offset:6144
  ds_read_b64_tr_b16 v[130:131], v17 offset:6656
  ds_read_b128 v[132:135], v20
  ds_read_b128 v[136:139], v20 offset:4096
  ds_read_b64_tr_b16 v[140:141], v15 offset:5632
  ds_read_b64_tr_b16 v[142:143], v15 offset:5760
  v_mfma_f32_32x32x16_bf16 v[32:47], v[192:195], v[196:199], v[32:47]
  v_mfma_f32_32x32x16_bf16 v[48:63], v[192:195], v[200:203], v[48:63]
  v_mfma_f32_32x32x16_bf16 v[64:79], v[204:207], v[200:203], v[64:79]
  s_waitcnt vmcnt(24) lgkmcnt(0)
  s_barrier
  v_add_u32 v16, 73728, v14
  v_add_u32 v17, 90112, v13
  v_xor_b32 v18, 32, v16
  v_xor_b32 v19, 64, v16
  v_xor_b32 v20, 96, v16
  ds_read_b64_tr_b16 v[144:145], v17 offset:0
  ds_read_b64_tr_b16 v[146:147], v17 offset:512
  ds_read_b128 v[148:151], v16
  ds_read_b128 v[152:155], v16 offset:4096
  ds_read_b64_tr_b16 v[156:157], v15 offset:6144
  ds_read_b64_tr_b16 v[158:159], v15 offset:6272
  v_mfma_f32_32x32x16_bf16 v[32:47], v[80:83], v[84:87], v[32:47]
  v_mfma_f32_32x32x16_bf16 v[48:63], v[80:83], v[88:91], v[48:63]
  v_mfma_f32_32x32x16_bf16 v[64:79], v[92:95], v[88:91], v[64:79]
  ds_read_b64_tr_b16 v[160:161], v17 offset:2048
  ds_read_b64_tr_b16 v[162:163], v17 offset:2560
  ds_read_b128 v[164:167], v18
  ds_read_b128 v[168:171], v18 offset:4096
  ds_read_b64_tr_b16 v[172:173], v15 offset:6656
  ds_read_b64_tr_b16 v[174:175], v15 offset:6784
  v_mfma_f32_32x32x16_bf16 v[32:47], v[96:99], v[100:103], v[32:47]
  v_mfma_f32_32x32x16_bf16 v[48:63], v[96:99], v[104:107], v[48:63]
  v_mfma_f32_32x32x16_bf16 v[64:79], v[108:111], v[104:107], v[64:79]
  ds_read_b64_tr_b16 v[176:177], v17 offset:4096
  ds_read_b64_tr_b16 v[178:179], v17 offset:4608
  ds_read_b128 v[180:183], v19
  ds_read_b128 v[184:187], v19 offset:4096
  ds_read_b64_tr_b16 v[188:189], v15 offset:7168
  ds_read_b64_tr_b16 v[190:191], v15 offset:7296
  v_mfma_f32_32x32x16_bf16 v[32:47], v[112:115], v[116:119], v[32:47]
  v_mfma_f32_32x32x16_bf16 v[48:63], v[112:115], v[120:123], v[48:63]
  v_mfma_f32_32x32x16_bf16 v[64:79], v[124:127], v[120:123], v[64:79]
  ds_read_b64_tr_b16 v[192:193], v17 offset:6144
  ds_read_b64_tr_b16 v[194:195], v17 offset:6656
  ds_read_b128 v[196:199], v20
  ds_read_b128 v[200:203], v20 offset:4096
  ds_read_b64_tr_b16 v[204:205], v15 offset:7680
  ds_read_b64_tr_b16 v[206:207], v15 offset:7808
  v_mfma_f32_32x32x16_bf16 v[32:47], v[128:131], v[132:135], v[32:47]
  v_mfma_f32_32x32x16_bf16 v[48:63], v[128:131], v[136:139], v[48:63]
  v_mfma_f32_32x32x16_bf16 v[64:79], v[140:143], v[136:139], v[64:79]
  s_waitcnt vmcnt(18) lgkmcnt(0)
  s_barrier
  v_add_u32 v16, 98304, v14
  v_add_u32 v17, 114688, v13
  v_xor_b32 v18, 32, v16
  v_xor_b32 v19, 64, v16
  v_xor_b32 v20, 96, v16
  ds_read_b64_tr_b16 v[80:81], v17 offset:0
  ds_read_b64_tr_b16 v[82:83], v17 offset:512
  ds_read_b128 v[84:87], v16
  ds_read_b128 v[88:91], v16 offset:4096
  ds_read_b64_tr_b16 v[92:93], v15 offset:8192
  ds_read_b64_tr_b16 v[94:95], v15 offset:8320
  v_mfma_f32_32x32x16_bf16 v[32:47], v[144:147], v[148:151], v[32:47]
  v_mfma_f32_32x32x16_bf16 v[48:63], v[144:147], v[152:155], v[48:63]
  v_mfma_f32_32x32x16_bf16 v[64:79], v[156:159], v[152:155], v[64:79]
  ds_read_b64_tr_b16 v[96:97], v17 offset:2048
  ds_read_b64_tr_b16 v[98:99], v17 offset:2560
  ds_read_b128 v[100:103], v18
  ds_read_b128 v[104:107], v18 offset:4096
  ds_read_b64_tr_b16 v[108:109], v15 offset:8704
  ds_read_b64_tr_b16 v[110:111], v15 offset:8832
  v_mfma_f32_32x32x16_bf16 v[32:47], v[160:163], v[164:167], v[32:47]
  v_mfma_f32_32x32x16_bf16 v[48:63], v[160:163], v[168:171], v[48:63]
  v_mfma_f32_32x32x16_bf16 v[64:79], v[172:175], v[168:171], v[64:79]
  ds_read_b64_tr_b16 v[112:113], v17 offset:4096
  ds_read_b64_tr_b16 v[114:115], v17 offset:4608
  ds_read_b128 v[116:119], v19
  ds_read_b128 v[120:123], v19 offset:4096
  ds_read_b64_tr_b16 v[124:125], v15 offset:9216
  ds_read_b64_tr_b16 v[126:127], v15 offset:9344
  v_mfma_f32_32x32x16_bf16 v[32:47], v[176:179], v[180:183], v[32:47]
  v_mfma_f32_32x32x16_bf16 v[48:63], v[176:179], v[184:187], v[48:63]
  v_mfma_f32_32x32x16_bf16 v[64:79], v[188:191], v[184:187], v[64:79]
  ds_read_b64_tr_b16 v[128:129], v17 offset:6144
  ds_read_b64_tr_b16 v[130:131], v17 offset:6656
  ds_read_b128 v[132:135], v20
  ds_read_b128 v[136:139], v20 offset:4096
  ds_read_b64_tr_b16 v[140:141], v15 offset:9728
  ds_read_b64_tr_b16 v[142:143], v15 offset:9856
  v_mfma_f32_32x32x16_bf16 v[32:47], v[192:195], v[196:199], v[32:47]
  v_mfma_f32_32x32x16_bf16 v[48:63], v[192:195], v[200:203], v[48:63]
  v_mfma_f32_32x32x16_bf16 v[64:79], v[204:207], v[200:203], v[64:79]
  s_waitcnt vmcnt(12) lgkmcnt(0)
  s_barrier
  v_add_u32 v16, 122880, v14
  v_add_u32 v17, 139264, v13
  v_xor_b32 v18, 32, v16
  v_xor_b32 v19, 64, v16
  v_xor_b32 v20, 96, v16
  ds_read_b64_tr_b16 v[144:145], v17 offset:0
  ds_read_b64_tr_b16 v[146:147], v17 offset:512
  ds_read_b128 v[148:151], v16
  ds_read_b128 v[152:155], v16 offset:4096
  ds_read_b64_tr_b16 v[156:157], v15 offset:10240
  ds_read_b64_tr_b16 v[158:159], v15 offset:10368
  v_mfma_f32_32x32x16_bf16 v[32:47], v[80:83], v[84:87], v[32:47]
  v_mfma_f32_32x32x16_bf16 v[48:63], v[80:83], v[88:91], v[48:63]
  v_mfma_f32_32x32x16_bf16 v[64:79], v[92:95], v[88:91], v[64:79]
  ds_read_b64_tr_b16 v[160:161], v17 offset:2048
  ds_read_b64_tr_b16 v[162:163], v17 offset:2560
  ds_read_b128 v[164:167], v18
  ds_read_b128 v[168:171], v18 offset:4096
  ds_read_b64_tr_b16 v[172:173], v15 offset:10752
  ds_read_b64_tr_b16 v[174:175], v15 offset:10880
  v_mfma_f32_32x32x16_bf16 v[32:47], v[96:99], v[100:103], v[32:47]
  v_mfma_f32_32x32x16_bf16 v[48:63], v[96:99], v[104:107], v[48:63]
  v_mfma_f32_32x32x16_bf16 v[64:79], v[108:111], v[104:107], v[64:79]
  ds_read_b64_tr_b16 v[176:177], v17 offset:4096
  ds_read_b64_tr_b16 v[178:179], v17 offset:4608
  ds_read_b128 v[180:183], v19
  ds_read_b128 v[184:187], v19 offset:4096
  ds_read_b64_tr_b16 v[188:189], v15 offset:11264
  ds_read_b64_tr_b16 v[190:191], v15 offset:11392
  v_mfma_f32_32x32x16_bf16 v[32:47], v[112:115], v[116:119], v[32:47]
  v_mfma_f32_32x32x16_bf16 v[48:63], v[112:115], v[120:123], v[48:63]
  v_mfma_f32_32x32x16_bf16 v[64:79], v[124:127], v[120:123], v[64:79]
  ds_read_b64_tr_b16 v[192:193], v17 offset:6144
  ds_read_b64_tr_b16 v[194:195], v17 offset:6656
  ds_read_b128 v[196:199], v20
  ds_read_b128 v[200:203], v20 offset:4096
  ds_read_b64_tr_b16 v[204:205], v15 offset:11776
  ds_read_b64_tr_b16 v[206:207], v15 offset:11904
  v_mfma_f32_32x32x16_bf16 v[32:47], v[128:131], v[132:135], v[32:47]
  v_mfma_f32_32x32x16_bf16 v[48:63], v[128:131], v[136:139], v[48:63]
  v_mfma_f32_32x32x16_bf16 v[64:79], v[140:143], v[136:139], v[64:79]
  s_waitcnt vmcnt(6) lgkmcnt(0)
  s_barrier
  v_add_u32 v16, 0, v14
  v_add_u32 v17, 16384, v13
  v_xor_b32 v18, 32, v16
  v_xor_b32 v19, 64, v16
  v_xor_b32 v20, 96, v16
  ds_read_b64_tr_b16 v[80:81], v17 offset:0
  ds_read_b64_tr_b16 v[82:83], v17 offset:512
  ds_read_b128 v[84:87], v16
  ds_read_b128 v[88:91], v16 offset:4096
  ds_read_b64_tr_b16 v[92:93], v15 offset:12288
  ds_read_b64_tr_b16 v[94:95], v15 offset:12416
  v_mfma_f32_32x32x16_bf16 v[32:47], v[144:147], v[148:151], v[32:47]
  v_mfma_f32_32x32x16_bf16 v[48:63], v[144:147], v[152:155], v[48:63]
  v_mfma_f32_32x32x16_bf16 v[64:79], v[156:159], v[152:155], v[64:79]
  ds_read_b64_tr_b16 v[96:97], v17 offset:2048
  ds_read_b64_tr_b16 v[98:99], v17 offset:2560
  ds_read_b128 v[100:103], v18
  ds_read_b128 v[104:107], v18 offset:4096
  ds_read_b64_tr_b16 v[108:109], v15 offset:12800
  ds_read_b64_tr_b16 v[110:111], v15 offset:12928
  v_mfma_f32_32x32x16_bf16 v[32:47], v[160:163], v[164:167], v[32:47]
  v_mfma_f32_32x32x16_bf16 v[48:63], v[160:163], v[168:171], v[48:63]
  v_mfma_f32_32x32x16_bf16 v[64:79], v[172:175], v[168:171], v[64:79]
  ds_read_b64_tr_b16 v[112:113], v17 offset:4096
  ds_read_b64_tr_b16 v[114:115], v17 offset:4608
  ds_read_b128 v[116:119], v19
  ds_read_b128 v[120:123], v19 offset:4096
  ds_read_b64_tr_b16 v[124:125], v15 offset:13312
  ds_read_b64_tr_b16 v[126:127], v15 offset:13440
  v_mfma_f32_32x32x16_bf16 v[32:47], v[176:179], v[180:183], v[32:47]
  v_mfma_f32_32x32x16_bf16 v[48:63], v[176:179], v[184:187], v[48:63]
  v_mfma_f32_32x32x16_bf16 v[64:79], v[188:191], v[184:187], v[64:79]
  ds_read_b64_tr_b16 v[128:129], v17 offset:6144
  ds_read_b64_tr_b16 v[130:131], v17 offset:6656
  ds_read_b128 v[132:135], v20
  ds_read_b128 v[136:139], v20 offset:4096
  ds_read_b64_tr_b16 v[140:141], v15 offset:13824
  ds_read_b64_tr_b16 v[142:143], v15 offset:13952
  v_mfma_f32_32x32x16_bf16 v[32:47], v[192:195], v[196:199], v[32:47]
  v_mfma_f32_32x32x16_bf16 v[48:63], v[192:195], v[200:203], v[48:63]
  v_mfma_f32_32x32x16_bf16 v[64:79], v[204:207], v[200:203], v[64:79]
  s_waitcnt vmcnt(0) lgkmcnt(0)
  s_barrier
  v_add_u32 v16, 24576, v14
  v_add_u32 v17, 40960, v13
  v_xor_b32 v18, 32, v16
  v_xor_b32 v19, 64, v16
  v_xor_b32 v20, 96, v16
  ds_read_b64_tr_b16 v[144:145], v17 offset:0
  ds_read_b64_tr_b16 v[146:147], v17 offset:512
  ds_read_b128 v[148:151], v16
  ds_read_b128 v[152:155], v16 offset:4096
  ds_read_b64_tr_b16 v[156:157], v15 offset:14336
  ds_read_b64_tr_b16 v[158:159], v15 offset:14464
  v_mfma_f32_32x32x16_bf16 v[32:47], v[80:83], v[84:87], v[32:47]
  v_mfma_f32_32x32x16_bf16 v[48:63], v[80:83], v[88:91], v[48:63]
  v_mfma_f32_32x32x16_bf16 v[64:79], v[92:95], v[88:91], v[64:79]
  ds_read_b64_tr_b16 v[160:161], v17 offset:2048
  ds_read_b64_tr_b16 v[162:163], v17 offset:2560
  ds_read_b128 v[164:167], v18
  ds_read_b128 v[168:171], v18 offset:4096
  ds_read_b64_tr_b16 v[172:173], v15 offset:14848
  ds_read_b64_tr_b16 v[174:175], v15 offset:14976
  v_mfma_f32_32x32x16_bf16 v[32:47], v[96:99], v[100:103], v[32:47]
  v_mfma_f32_32x32x16_bf16 v[48:63], v[96:99], v[104:107], v[48:63]
  v_mfma_f32_32x32x16_bf16 v[64:79], v[108:111], v[104:107], v[64:79]
  ds_read_b64_tr_b16 v[176:177], v17 offset:4096
  ds_read_b64_tr_b16 v[178:179], v17 offset:4608
  ds_read_b128 v[180:183], v19
  ds_read_b128 v[184:187], v19 offset:4096
  ds_read_b64_tr_b16 v[188:189], v15 offset:15360
  ds_read_b64_tr_b16 v[190:191], v15 offset:15488
  v_mfma_f32_32x32x16_bf16 v[32:47], v[112:115], v[116:119], v[32:47]
  v_mfma_f32_32x32x16_bf16 v[48:63], v[112:115], v[120:123], v[48:63]
  v_mfma_f32_32x32x16_bf16 v[64:79], v[124:127], v[120:123], v[64:79]
  ds_read_b64_tr_b16 v[192:193], v17 offset:6144
  ds_read_b64_tr_b16 v[194:195], v17 offset:6656
  ds_read_b128 v[196:199], v20
  ds_read_b128 v[200:203], v20 offset:4096
  ds_read_b64_tr_b16 v[204:205], v15 offset:15872
  ds_read_b64_tr_b16 v[206:207], v15 offset:16000
  v_mfma_f32_32x32x16_bf16 v[32:47], v[128:131], v[132:135], v[32:47]
  v_mfma_f32_32x32x16_bf16 v[48:63], v[128:131], v[136:139], v[48:63]
  v_mfma_f32_32x32x16_bf16 v[64:79], v[140:143], v[136:139], v[64:79]
  s_waitcnt lgkmcnt(15)
  v_mfma_f32_32x32x16_bf16 v[32:47], v[144:147], v[148:151], v[32:47]
  v_mfma_f32_32x32x16_bf16 v[48:63], v[144:147], v[152:155], v[48:63]
  v_mfma_f32_32x32x16_bf16 v[64:79], v[156:159], v[152:155], v[64:79]
  s_waitcnt lgkmcnt(12)
  v_mfma_f32_32x32x16_bf16 v[32:47], v[160:163], v[164:167], v[32:47]
  v_mfma_f32_32x32x16_bf16 v[48:63], v[160:163], v[168:171], v[48:63]
  v_mfma_f32_32x32x16_bf16 v[64:79], v[172:175], v[168:171], v[64:79]
  s_waitcnt lgkmcnt(6)
  v_mfma_f32_32x32x16_bf16 v[32:47], v[176:179], v[180:183], v[32:47]
  v_mfma_f32_32x32x16_bf16 v[48:63], v[176:179], v[184:187], v[48:63]
  v_mfma_f32_32x32x16_bf16 v[64:79], v[188:191], v[184:187], v[64:79]
  s_waitcnt lgkmcnt(0)
  v_mfma_f32_32x32x16_bf16 v[32:47], v[192:195], v[196:199], v[32:47]
  v_mfma_f32_32x32x16_bf16 v[48:63], v[192:195], v[200:203], v[48:63]
  v_mfma_f32_32x32x16_bf16 v[64:79], v[204:207], v[200:203], v[64:79]
  s_nop 15
  s_lshl_b32 s50, s45, 2
  s_lshr_b32 s51, s44, 1
  s_add_u32 s50, s50, s51
  s_lshl_b32 s50, s50, 10
  s_add_u32 s50, s50, 2097152
  v_cvt_pk_bf16_f32 v64, v64, v65
  v_cvt_pk_bf16_f32 v65, v66, v67
  v_cvt_pk_bf16_f32 v66, v68, v69
  v_cvt_pk_bf16_f32 v67, v70, v71
  v_lshlrev_b32 v2, 4, v0
  buffer_store_dwordx4 v[64:67], v2, s[24:27], s50 offen
  s_branch .Lk1_qepi
.Lk1_kv3:
  s_waitcnt vmcnt(12) lgkmcnt(0)
  s_barrier
  v_add_u32 v16, 0, v14
  v_add_u32 v17, 16384, v13
  v_xor_b32 v18, 32, v16
  v_xor_b32 v19, 64, v16
  v_xor_b32 v20, 96, v16
  ds_read_b64_tr_b16 v[80:81], v17 offset:0
  ds_read_b64_tr_b16 v[82:83], v17 offset:512
  ds_read_b128 v[84:87], v16
  ds_read_b128 v[88:91], v16 offset:4096
  ds_read_b64_tr_b16 v[92:93], v15 offset:0
  ds_read_b64_tr_b16 v[94:95], v15 offset:128
  s_mov_b32 s52, 384
  s_add_u32 m0, s47, 73728
  s_nop 0
  buffer_load_dwordx4 v10, s[28:31], s52 offen lds
  s_mov_b32 s52, 33152
  s_add_u32 m0, s47, 77824
  s_nop 0
  buffer_load_dwordx4 v10, s[28:31], s52 offen lds
  s_mov_b32 s52, 65920
  s_add_u32 m0, s47, 81920
  s_nop 0
  buffer_load_dwordx4 v10, s[28:31], s52 offen lds
  ds_read_b64_tr_b16 v[96:97], v17 offset:2048
  ds_read_b64_tr_b16 v[98:99], v17 offset:2560
  ds_read_b128 v[100:103], v18
  ds_read_b128 v[104:107], v18 offset:4096
  ds_read_b64_tr_b16 v[108:109], v15 offset:512
  ds_read_b64_tr_b16 v[110:111], v15 offset:640
  s_mov_b32 s52, 98688
  s_add_u32 m0, s47, 86016
  s_nop 0
  buffer_load_dwordx4 v10, s[28:31], s52 offen lds
  s_mov_b32 s52, 196608
  s_add_u32 m0, s47, 90112
  s_nop 0
  buffer_load_dwordx4 v11, s[32:35], s52 offen lds
  s_mov_b32 s52, 229376
  s_add_u32 m0, s47, 94208
  s_nop 0
  buffer_load_dwordx4 v11, s[32:35], s52 offen lds
  ds_read_b64_tr_b16 v[112:113], v17 offset:4096
  ds_read_b64_tr_b16 v[114:115], v17 offset:4608
  ds_read_b128 v[116:119], v19
  ds_read_b128 v[120:123], v19 offset:4096
  ds_read_b64_tr_b16 v[124:125], v15 offset:1024
  ds_read_b64_tr_b16 v[126:127], v15 offset:1152
  s_mov_b32 s52, 512
  s_add_u32 m0, s47, 98304
  s_nop 0
  buffer_load_dwordx4 v10, s[28:31], s52 offen lds
  s_mov_b32 s52, 33280
  s_add_u32 m0, s47, 102400
  s_nop 0
  buffer_load_dwordx4 v10, s[28:31], s52 offen lds
  s_mov_b32 s52, 66048
  s_add_u32 m0, s47, 106496
  s_nop 0
  buffer_load_dwordx4 v10, s[28:31], s52 offen lds
  ds_read_b64_tr_b16 v[128:129], v17 offset:6144
  ds_read_b64_tr_b16 v[130:131], v17 offset:6656
  ds_read_b128 v[132:135], v20
  ds_read_b128 v[136:139], v20 offset:4096
  ds_read_b64_tr_b16 v[140:141], v15 offset:1536
  ds_read_b64_tr_b16 v[142:143], v15 offset:1664
  s_mov_b32 s52, 98816
  s_add_u32 m0, s47, 110592
  s_nop 0
  buffer_load_dwordx4 v10, s[28:31], s52 offen lds
  s_mov_b32 s52, 262144
  s_add_u32 m0, s47, 114688
  s_nop 0
  buffer_load_dwordx4 v11, s[32:35], s52 offen lds
  s_mov_b32 s52, 294912
  s_add_u32 m0, s47, 118784
  s_nop 0
  buffer_load_dwordx4 v11, s[32:35], s52 offen lds
  s_waitcnt vmcnt(18) lgkmcnt(0)
  s_barrier
  v_add_u32 v16, 24576, v14
  v_add_u32 v17, 40960, v13
  v_xor_b32 v18, 32, v16
  v_xor_b32 v19, 64, v16
  v_xor_b32 v20, 96, v16
  ds_read_b64_tr_b16 v[144:145], v17 offset:0
  ds_read_b64_tr_b16 v[146:147], v17 offset:512
  ds_read_b128 v[148:151], v16
  ds_read_b128 v[152:155], v16 offset:4096
  ds_read_b64_tr_b16 v[156:157], v15 offset:2048
  ds_read_b64_tr_b16 v[158:159], v15 offset:2176
  v_mfma_f32_32x32x16_bf16 v[32:47], v[80:83], v[84:87], 0
  v_mfma_f32_32x32x16_bf16 v[48:63], v[80:83], v[88:91], 0
  v_mfma_f32_32x32x16_bf16 v[64:79], v[88:91], v[92:95], 0
  s_mov_b32 s52, 640
  s_add_u32 m0, s47, 122880
  s_nop 0
  buffer_load_dwordx4 v10, s[28:31], s52 offen lds
  s_mov_b32 s52, 33408
  s_add_u32 m0, s47, 126976
  s_nop 0
  buffer_load_dwordx4 v10, s[28:31], s52 offen lds
  s_mov_b32 s52, 66176
  s_add_u32 m0, s47, 131072
  s_nop 0
  buffer_load_dwordx4 v10, s[28:31], s52 offen lds
  ds_read_b64_tr_b16 v[160:161], v17 offset:2048
  ds_read_b64_tr_b16 v[162:163], v17 offset:2560
  ds_read_b128 v[164:167], v18
  ds_read_b128 v[168:171], v18 offset:4096
  ds_read_b64_tr_b16 v[172:173], v15 offset:2560
  ds_read_b64_tr_b16 v[174:175], v15 offset:2688
  v_mfma_f32_32x32x16_bf16 v[32:47], v[96:99], v[100:103], v[32:47]
  v_mfma_f32_32x32x16_bf16 v[48:63], v[96:99], v[104:107], v[48:63]
  v_mfma_f32_32x32x16_bf16 v[64:79], v[104:107], v[108:111], v[64:79]
  s_mov_b32 s52, 98944
  s_add_u32 m0, s47, 135168
  s_nop 0
  buffer_load_dwordx4 v10, s[28:31], s52 offen lds
  s_mov_b32 s52, 327680
  s_add_u32 m0, s47, 139264
  s_nop 0
  buffer_load_dwordx4 v11, s[32:35], s52 offen lds
  s_mov_b32 s52, 360448
  s_add_u32 m0, s47, 143360
  s_nop 0
  buffer_load_dwordx4 v11, s[32:35], s52 offen lds
  ds_read_b64_tr_b16 v[176:177], v17 offset:4096
  ds_read_b64_tr_b16 v[178:179], v17 offset:4608
  ds_read_b128 v[180:183], v19
  ds_read_b128 v[184:187], v19 offset:4096
  ds_read_b64_tr_b16 v[188:189], v15 offset:3072
  ds_read_b64_tr_b16 v[190:191], v15 offset:3200
  v_mfma_f32_32x32x16_bf16 v[32:47], v[112:115], v[116:119], v[32:47]
  v_mfma_f32_32x32x16_bf16 v[48:63], v[112:115], v[120:123], v[48:63]
  v_mfma_f32_32x32x16_bf16 v[64:79], v[120:123], v[124:127], v[64:79]
  s_mov_b32 s52, 768
  s_add_u32 m0, s47, 0
  s_nop 0
  buffer_load_dwordx4 v10, s[28:31], s52 offen lds
  s_mov_b32 s52, 33536
  s_add_u32 m0, s47, 4096
  s_nop 0
  buffer_load_dwordx4 v10, s[28:31], s52 offen lds
  s_mov_b32 s52, 66304
  s_add_u32 m0, s47, 8192
  s_nop 0
  buffer_load_dwordx4 v10, s[28:31], s52 offen lds
  ds_read_b64_tr_b16 v[192:193], v17 offset:6144
  ds_read_b64_tr_b16 v[194:195], v17 offset:6656
  ds_read_b128 v[196:199], v20
  ds_read_b128 v[200:203], v20 offset:4096
  ds_read_b64_tr_b16 v[204:205], v15 offset:3584
  ds_read_b64_tr_b16 v[206:207], v15 offset:3712
  v_mfma_f32_32x32x16_bf16 v[32:47], v[128:131], v[132:135], v[32:47]
  v_mfma_f32_32x32x16_bf16 v[48:63], v[128:131], v[136:139], v[48:63]
  v_mfma_f32_32x32x16_bf16 v[64:79], v[136:139], v[140:143], v[64:79]
  s_mov_b32 s52, 99072
  s_add_u32 m0, s47, 12288
  s_nop 0
  buffer_load_dwordx4 v10, s[28:31], s52 offen lds
  s_mov_b32 s52, 393216
  s_add_u32 m0, s47, 16384
  s_nop 0
  buffer_load_dwordx4 v11, s[32:35], s52 offen lds
  s_mov_b32 s52, 425984
  s_add_u32 m0, s47, 20480
  s_nop 0
  buffer_load_dwordx4 v11, s[32:35], s52 offen lds
  s_waitcnt vmcnt(24) lgkmcnt(0)
  s_barrier
  v_add_u32 v16, 49152, v14
  v_add_u32 v17, 65536, v13
  v_xor_b32 v18, 32, v16
  v_xor_b32 v19, 64, v16
  v_xor_b32 v20, 96, v16
  ds_read_b64_tr_b16 v[80:81], v17 offset:0
  ds_read_b64_tr_b16 v[82:83], v17 offset:512
  ds_read_b128 v[84:87], v16
  ds_read_b128 v[88:91], v16 offset:4096
  ds_read_b64_tr_b16 v[92:93], v15 offset:4096
  ds_read_b64_tr_b16 v[94:95], v15 offset:4224
  v_mfma_f32_32x32x16_bf16 v[32:47], v[144:147], v[148:151], v[32:47]
  v_mfma_f32_32x32x16_bf16 v[48:63], v[144:147], v[152:155], v[48:63]
  v_mfma_f32_32x32x16_bf16 v[64:79], v[152:155], v[156:159], v[64:79]
  s_mov_b32 s52, 896
  s_add_u32 m0, s47, 24576
  s_nop 0
  buffer_load_dwordx4 v10, s[28:31], s52 offen lds
  s_mov_b32 s52, 33664
  s_add_u32 m0, s47, 28672
  s_nop 0
  buffer_load_dwordx4 v10, s[28:31], s52 offen lds
  ds_read_b64_tr_b16 v[96:97], v17 offset:2048
  ds_read_b64_tr_b16 v[98:99], v17 offset:2560
  ds_read_b128 v[100:103], v18
  ds_read_b128 v[104:107], v18 offset:4096
  ds_read_b64_tr_b16 v[108:109], v15 offset:4608
  ds_read_b64_tr_b16 v[110:111], v15 offset:4736
  v_mfma_f32_32x32x16_bf16 v[32:47], v[160:163], v[164:167], v[32:47]
  v_mfma_f32_32x32x16_bf16 v[48:63], v[160:163], v[168:171], v[48:63]
  v_mfma_f32_32x32x16_bf16 v[64:79], v[168:171], v[172:175], v[64:79]
  s_mov_b32 s52, 66432
  s_add_u32 m0, s47, 32768
  s_nop 0
  buffer_load_dwordx4 v10, s[28:31], s52 offen lds
  s_mov_b32 s52, 99200
  s_add_u32 m0, s47, 36864
  s_nop 0
  buffer_load_dwordx4 v10, s[28:31], s52 offen lds
  ds_read_b64_tr_b16 v[112:113], v17 offset:4096
  ds_read_b64_tr_b16 v[114:115], v17 offset:4608
  ds_read_b128 v[116:119], v19
  ds_read_b128 v[120:123], v19 offset:4096
  ds_read_b64_tr_b16 v[124:125], v15 offset:5120
  ds_read_b64_tr_b16 v[126:127], v15 offset:5248
  v_mfma_f32_32x32x16_bf16 v[32:47], v[176:179], v[180:183], v[32:47]
  v_mfma_f32_32x32x16_bf16 v[48:63], v[176:179], v[184:187], v[48:63]
  v_mfma_f32_32x32x16_bf16 v[64:79], v[184:187], v[188:191], v[64:79]
  s_mov_b32 s52, 458752
  s_add_u32 m0, s47, 40960
  s_nop 0
  buffer_load_dwordx4 v11, s[32:35], s52 offen lds
  s_mov_b32 s52, 491520
  s_add_u32 m0, s47, 45056
  s_nop 0
  buffer_load_dwordx4 v11, s[32:35], s52 offen lds
  ds_read_b64_tr_b16 v[128:129], v17 offset:6144
  ds_read_b64_tr_b16 v[130:131], v17 offset:6656
  ds_read_b128 v[132:135], v20
  ds_read_b128 v[136:139], v20 offset:4096
  ds_read_b64_tr_b16 v[140:141], v15 offset:5632
  ds_read_b64_tr_b16 v[142:143], v15 offset:5760
  v_mfma_f32_32x32x16_bf16 v[32:47], v[192:195], v[196:199], v[32:47]
  v_mfma_f32_32x32x16_bf16 v[48:63], v[192:195], v[200:203], v[48:63]
  v_mfma_f32_32x32x16_bf16 v[64:79], v[200:203], v[204:207], v[64:79]
  s_waitcnt vmcnt(24) lgkmcnt(0)
  s_barrier
  v_add_u32 v16, 73728, v14
  v_add_u32 v17, 90112, v13
  v_xor_b32 v18, 32, v16
  v_xor_b32 v19, 64, v16
  v_xor_b32 v20, 96, v16
  ds_read_b64_tr_b16 v[144:145], v17 offset:0
  ds_read_b64_tr_b16 v[146:147], v17 offset:512
  ds_read_b128 v[148:151], v16
  ds_read_b128 v[152:155], v16 offset:4096
  ds_read_b64_tr_b16 v[156:157], v15 offset:6144
  ds_read_b64_tr_b16 v[158:159], v15 offset:6272
  v_mfma_f32_32x32x16_bf16 v[32:47], v[80:83], v[84:87], v[32:47]
  v_mfma_f32_32x32x16_bf16 v[48:63], v[80:83], v[88:91], v[48:63]
  v_mfma_f32_32x32x16_bf16 v[64:79], v[88:91], v[92:95], v[64:79]
  ds_read_b64_tr_b16 v[160:161], v17 offset:2048
  ds_read_b64_tr_b16 v[162:163], v17 offset:2560
  ds_read_b128 v[164:167], v18
  ds_read_b128 v[168:171], v18 offset:4096
  ds_read_b64_tr_b16 v[172:173], v15 offset:6656
  ds_read_b64_tr_b16 v[174:175], v15 offset:6784
  v_mfma_f32_32x32x16_bf16 v[32:47], v[96:99], v[100:103], v[32:47]
  v_mfma_f32_32x32x16_bf16 v[48:63], v[96:99], v[104:107], v[48:63]
  v_mfma_f32_32x32x16_bf16 v[64:79], v[104:107], v[108:111], v[64:79]
  ds_read_b64_tr_b16 v[176:177], v17 offset:4096
  ds_read_b64_tr_b16 v[178:179], v17 offset:4608
  ds_read_b128 v[180:183], v19
  ds_read_b128 v[184:187], v19 offset:4096
  ds_read_b64_tr_b16 v[188:189], v15 offset:7168
  ds_read_b64_tr_b16 v[190:191], v15 offset:7296
  v_mfma_f32_32x32x16_bf16 v[32:47], v[112:115], v[116:119], v[32:47]
  v_mfma_f32_32x32x16_bf16 v[48:63], v[112:115], v[120:123], v[48:63]
  v_mfma_f32_32x32x16_bf16 v[64:79], v[120:123], v[124:127], v[64:79]
  ds_read_b64_tr_b16 v[192:193], v17 offset:6144
  ds_read_b64_tr_b16 v[194:195], v17 offset:6656
  ds_read_b128 v[196:199], v20
  ds_read_b128 v[200:203], v20 offset:4096
  ds_read_b64_tr_b16 v[204:205], v15 offset:7680
  ds_read_b64_tr_b16 v[206:207], v15 offset:7808
  v_mfma_f32_32x32x16_bf16 v[32:47], v[128:131], v[132:135], v[32:47]
  v_mfma_f32_32x32x16_bf16 v[48:63], v[128:131], v[136:139], v[48:63]
  v_mfma_f32_32x32x16_bf16 v[64:79], v[136:139], v[140:143], v[64:79]
  s_waitcnt vmcnt(18) lgkmcnt(0)
  s_barrier
  v_add_u32 v16, 98304, v14
  v_add_u32 v17, 114688, v13
  v_xor_b32 v18, 32, v16
  v_xor_b32 v19, 64, v16
  v_xor_b32 v20, 96, v16
  ds_read_b64_tr_b16 v[80:81], v17 offset:0
  ds_read_b64_tr_b16 v[82:83], v17 offset:512
  ds_read_b128 v[84:87], v16
  ds_read_b128 v[88:91], v16 offset:4096
  ds_read_b64_tr_b16 v[92:93], v15 offset:8192
  ds_read_b64_tr_b16 v[94:95], v15 offset:8320
  v_mfma_f32_32x32x16_bf16 v[32:47], v[144:147], v[148:151], v[32:47]
  v_mfma_f32_32x32x16_bf16 v[48:63], v[144:147], v[152:155], v[48:63]
  v_mfma_f32_32x32x16_bf16 v[64:79], v[152:155], v[156:159], v[64:79]
  ds_read_b64_tr_b16 v[96:97], v17 offset:2048
  ds_read_b64_tr_b16 v[98:99], v17 offset:2560
  ds_read_b128 v[100:103], v18
  ds_read_b128 v[104:107], v18 offset:4096
  ds_read_b64_tr_b16 v[108:109], v15 offset:8704
  ds_read_b64_tr_b16 v[110:111], v15 offset:8832
  v_mfma_f32_32x32x16_bf16 v[32:47], v[160:163], v[164:167], v[32:47]
  v_mfma_f32_32x32x16_bf16 v[48:63], v[160:163], v[168:171], v[48:63]
  v_mfma_f32_32x32x16_bf16 v[64:79], v[168:171], v[172:175], v[64:79]
  ds_read_b64_tr_b16 v[112:113], v17 offset:4096
  ds_read_b64_tr_b16 v[114:115], v17 offset:4608
  ds_read_b128 v[116:119], v19
  ds_read_b128 v[120:123], v19 offset:4096
  ds_read_b64_tr_b16 v[124:125], v15 offset:9216
  ds_read_b64_tr_b16 v[126:127], v15 offset:9344
  v_mfma_f32_32x32x16_bf16 v[32:47], v[176:179], v[180:183], v[32:47]
  v_mfma_f32_32x32x16_bf16 v[48:63], v[176:179], v[184:187], v[48:63]
  v_mfma_f32_32x32x16_bf16 v[64:79], v[184:187], v[188:191], v[64:79]
  ds_read_b64_tr_b16 v[128:129], v17 offset:6144
  ds_read_b64_tr_b16 v[130:131], v17 offset:6656
  ds_read_b128 v[132:135], v20
  ds_read_b128 v[136:139], v20 offset:4096
  ds_read_b64_tr_b16 v[140:141], v15 offset:9728
  ds_read_b64_tr_b16 v[142:143], v15 offset:9856
  v_mfma_f32_32x32x16_bf16 v[32:47], v[192:195], v[196:199], v[32:47]
  v_mfma_f32_32x32x16_bf16 v[48:63], v[192:195], v[200:203], v[48:63]
  v_mfma_f32_32x32x16_bf16 v[64:79], v[200:203], v[204:207], v[64:79]
  s_waitcnt vmcnt(12) lgkmcnt(0)
  s_barrier
  v_add_u32 v16, 122880, v14
  v_add_u32 v17, 139264, v13
  v_xor_b32 v18, 32, v16
  v_xor_b32 v19, 64, v16
  v_xor_b32 v20, 96, v16
  ds_read_b64_tr_b16 v[144:145], v17 offset:0
  ds_read_b64_tr_b16 v[146:147], v17 offset:512
  ds_read_b128 v[148:151], v16
  ds_read_b128 v[152:155], v16 offset:4096
  ds_read_b64_tr_b16 v[156:157], v15 offset:10240
  ds_read_b64_tr_b16 v[158:159], v15 offset:10368
  v_mfma_f32_32x32x16_bf16 v[32:47], v[80:83], v[84:87], v[32:47]
  v_mfma_f32_32x32x16_bf16 v[48:63], v[80:83], v[88:91], v[48:63]
  v_mfma_f32_32x32x16_bf16 v[64:79], v[88:91], v[92:95], v[64:79]
  ds_read_b64_tr_b16 v[160:161], v17 offset:2048
  ds_read_b64_tr_b16 v[162:163], v17 offset:2560
  ds_read_b128 v[164:167], v18
  ds_read_b128 v[168:171], v18 offset:4096
  ds_read_b64_tr_b16 v[172:173], v15 offset:10752
  ds_read_b64_tr_b16 v[174:175], v15 offset:10880
  v_mfma_f32_32x32x16_bf16 v[32:47], v[96:99], v[100:103], v[32:47]
  v_mfma_f32_32x32x16_bf16 v[48:63], v[96:99], v[104:107], v[48:63]
  v_mfma_f32_32x32x16_bf16 v[64:79], v[104:107], v[108:111], v[64:79]
  ds_read_b64_tr_b16 v[176:177], v17 offset:4096
  ds_read_b64_tr_b16 v[178:179], v17 offset:4608
  ds_read_b128 v[180:183], v19
  ds_read_b128 v[184:187], v19 offset:4096
  ds_read_b64_tr_b16 v[188:189], v15 offset:11264
  ds_read_b64_tr_b16 v[190:191], v15 offset:11392
  v_mfma_f32_32x32x16_bf16 v[32:47], v[112:115], v[116:119], v[32:47]
  v_mfma_f32_32x32x16_bf16 v[48:63], v[112:115], v[120:123], v[48:63]
  v_mfma_f32_32x32x16_bf16 v[64:79], v[120:123], v[124:127], v[64:79]
  ds_read_b64_tr_b16 v[192:193], v17 offset:6144
  ds_read_b64_tr_b16 v[194:195], v17 offset:6656
  ds_read_b128 v[196:199], v20
  ds_read_b128 v[200:203], v20 offset:4096
  ds_read_b64_tr_b16 v[204:205], v15 offset:11776
  ds_read_b64_tr_b16 v[206:207], v15 offset:11904
  v_mfma_f32_32x32x16_bf16 v[32:47], v[128:131], v[132:135], v[32:47]
  v_mfma_f32_32x32x16_bf16 v[48:63], v[128:131], v[136:139], v[48:63]
  v_mfma_f32_32x32x16_bf16 v[64:79], v[136:139], v[140:143], v[64:79]
  s_waitcnt vmcnt(6) lgkmcnt(0)
  s_barrier
  v_add_u32 v16, 0, v14
  v_add_u32 v17, 16384, v13
  v_xor_b32 v18, 32, v16
  v_xor_b32 v19, 64, v16
  v_xor_b32 v20, 96, v16
  ds_read_b64_tr_b16 v[80:81], v17 offset:0
  ds_read_b64_tr_b16 v[82:83], v17 offset:512
  ds_read_b128 v[84:87], v16
  ds_read_b128 v[88:91], v16 offset:4096
  ds_read_b64_tr_b16 v[92:93], v15 offset:12288
  ds_read_b64_tr_b16 v[94:95], v15 offset:12416
  v_mfma_f32_32x32x16_bf16 v[32:47], v[144:147], v[148:151], v[32:47]
  v_mfma_f32_32x32x16_bf16 v[48:63], v[144:147], v[152:155], v[48:63]
  v_mfma_f32_32x32x16_bf16 v[64:79], v[152:155], v[156:159], v[64:79]
  ds_read_b64_tr_b16 v[96:97], v17 offset:2048
  ds_read_b64_tr_b16 v[98:99], v17 offset:2560
  ds_read_b128 v[100:103], v18
  ds_read_b128 v[104:107], v18 offset:4096
  ds_read_b64_tr_b16 v[108:109], v15 offset:12800
  ds_read_b64_tr_b16 v[110:111], v15 offset:12928
  v_mfma_f32_32x32x16_bf16 v[32:47], v[160:163], v[164:167], v[32:47]
  v_mfma_f32_32x32x16_bf16 v[48:63], v[160:163], v[168:171], v[48:63]
  v_mfma_f32_32x32x16_bf16 v[64:79], v[168:171], v[172:175], v[64:79]
  ds_read_b64_tr_b16 v[112:113], v17 offset:4096
  ds_read_b64_tr_b16 v[114:115], v17 offset:4608
  ds_read_b128 v[116:119], v19
  ds_read_b128 v[120:123], v19 offset:4096
  ds_read_b64_tr_b16 v[124:125], v15 offset:13312
  ds_read_b64_tr_b16 v[126:127], v15 offset:13440
  v_mfma_f32_32x32x16_bf16 v[32:47], v[176:179], v[180:183], v[32:47]
  v_mfma_f32_32x32x16_bf16 v[48:63], v[176:179], v[184:187], v[48:63]
  v_mfma_f32_32x32x16_bf16 v[64:79], v[184:187], v[188:191], v[64:79]
  ds_read_b64_tr_b16 v[128:129], v17 offset:6144
  ds_read_b64_tr_b16 v[130:131], v17 offset:6656
  ds_read_b128 v[132:135], v20
  ds_read_b128 v[136:139], v20 offset:4096
  ds_read_b64_tr_b16 v[140:141], v15 offset:13824
  ds_read_b64_tr_b16 v[142:143], v15 offset:13952
  v_mfma_f32_32x32x16_bf16 v[32:47], v[192:195], v[196:199], v[32:47]
  v_mfma_f32_32x32x16_bf16 v[48:63], v[192:195], v[200:203], v[48:63]
  v_mfma_f32_32x32x16_bf16 v[64:79], v[200:203], v[204:207], v[64:79]
  s_waitcnt vmcnt(0) lgkmcnt(0)
  s_barrier
  v_add_u32 v16, 24576, v14
  v_add_u32 v17, 40960, v13
  v_xor_b32 v18, 32, v16
  v_xor_b32 v19, 64, v16
  v_xor_b32 v20, 96, v16
  ds_read_b64_tr_b16 v[144:145], v17 offset:0
  ds_read_b64_tr_b16 v[146:147], v17 offset:512
  ds_read_b128 v[148:151], v16
  ds_read_b128 v[152:155], v16 offset:4096
  ds_read_b64_tr_b16 v[156:157], v15 offset:14336
  ds_read_b64_tr_b16 v[158:159], v15 offset:14464
  v_mfma_f32_32x32x16_bf16 v[32:47], v[80:83], v[84:87], v[32:47]
  v_mfma_f32_32x32x16_bf16 v[48:63], v[80:83], v[88:91], v[48:63]
  v_mfma_f32_32x32x16_bf16 v[64:79], v[88:91], v[92:95], v[64:79]
  ds_read_b64_tr_b16 v[160:161], v17 offset:2048
  ds_read_b64_tr_b16 v[162:163], v17 offset:2560
  ds_read_b128 v[164:167], v18
  ds_read_b128 v[168:171], v18 offset:4096
  ds_read_b64_tr_b16 v[172:173], v15 offset:14848
  ds_read_b64_tr_b16 v[174:175], v15 offset:14976
  v_mfma_f32_32x32x16_bf16 v[32:47], v[96:99], v[100:103], v[32:47]
  v_mfma_f32_32x32x16_bf16 v[48:63], v[96:99], v[104:107], v[48:63]
  v_mfma_f32_32x32x16_bf16 v[64:79], v[104:107], v[108:111], v[64:79]
  ds_read_b64_tr_b16 v[176:177], v17 offset:4096
  ds_read_b64_tr_b16 v[178:179], v17 offset:4608
  ds_read_b128 v[180:183], v19
  ds_read_b128 v[184:187], v19 offset:4096
  ds_read_b64_tr_b16 v[188:189], v15 offset:15360
  ds_read_b64_tr_b16 v[190:191], v15 offset:15488
  v_mfma_f32_32x32x16_bf16 v[32:47], v[112:115], v[116:119], v[32:47]
  v_mfma_f32_32x32x16_bf16 v[48:63], v[112:115], v[120:123], v[48:63]
  v_mfma_f32_32x32x16_bf16 v[64:79], v[120:123], v[124:127], v[64:79]
  ds_read_b64_tr_b16 v[192:193], v17 offset:6144
  ds_read_b64_tr_b16 v[194:195], v17 offset:6656
  ds_read_b128 v[196:199], v20
  ds_read_b128 v[200:203], v20 offset:4096
  ds_read_b64_tr_b16 v[204:205], v15 offset:15872
  ds_read_b64_tr_b16 v[206:207], v15 offset:16000
  v_mfma_f32_32x32x16_bf16 v[32:47], v[128:131], v[132:135], v[32:47]
  v_mfma_f32_32x32x16_bf16 v[48:63], v[128:131], v[136:139], v[48:63]
  v_mfma_f32_32x32x16_bf16 v[64:79], v[136:139], v[140:143], v[64:79]
  s_waitcnt lgkmcnt(15)
  v_mfma_f32_32x32x16_bf16 v[32:47], v[144:147], v[148:151], v[32:47]
  v_mfma_f32_32x32x16_bf16 v[48:63], v[144:147], v[152:155], v[48:63]
  v_mfma_f32_32x32x16_bf16 v[64:79], v[152:155], v[156:159], v[64:79]
  s_waitcnt lgkmcnt(12)
  v_mfma_f32_32x32x16_bf16 v[32:47], v[160:163], v[164:167], v[32:47]
  v_mfma_f32_32x32x16_bf16 v[48:63], v[160:163], v[168:171], v[48:63]
  v_mfma_f32_32x32x16_bf16 v[64:79], v[168:171], v[172:175], v[64:79]
  s_waitcnt lgkmcnt(6)
  v_mfma_f32_32x32x16_bf16 v[32:47], v[176:179], v[180:183], v[32:47]
  v_mfma_f32_32x32x16_bf16 v[48:63], v[176:179], v[184:187], v[48:63]
  v_mfma_f32_32x32x16_bf16 v[64:79], v[184:187], v[188:191], v[64:79]
  s_waitcnt lgkmcnt(0)
  v_mfma_f32_32x32x16_bf16 v[32:47], v[192:195], v[196:199], v[32:47]
  v_mfma_f32_32x32x16_bf16 v[48:63], v[192:195], v[200:203], v[48:63]
  v_mfma_f32_32x32x16_bf16 v[64:79], v[200:203], v[204:207], v[64:79]
  s_nop 15
  s_lshl_b32 s50, s45, 2
  s_lshr_b32 s51, s44, 1
  s_add_u32 s50, s50, s51
  s_lshl_b32 s50, s50, 10
  s_add_u32 s50, s50, 2162688
  v_cvt_pk_bf16_f32 v64, v64, v65
  v_cvt_pk_bf16_f32 v65, v66, v67
  v_cvt_pk_bf16_f32 v66, v68, v69
  v_cvt_pk_bf16_f32 v67, v70, v71
  v_cvt_pk_bf16_f32 v68, v72, v73
  v_cvt_pk_bf16_f32 v69, v74, v75
  v_cvt_pk_bf16_f32 v70, v76, v77
  v_cvt_pk_bf16_f32 v71, v78, v79
  v_bfe_u32 v2, v0, 4, 1
  v_cmp_eq_u32 vcc, 1, v2
  v_lshlrev_b32 v2, 9, v2
  v_lshrrev_b32 v3, 5, v0
  v_lshl_add_u32 v2, v3, 8, v2
  v_and_b32 v3, 15, v0
  v_lshl_add_u32 v2, v3, 4, v2
  v_cndmask_b32 v64, v64, v68, vcc
  v_cndmask_b32 v65, v65, v69, vcc
  v_cndmask_b32 v66, v66, v70, vcc
  v_cndmask_b32 v67, v67, v71, vcc
  buffer_store_dwordx4 v[64:67], v2, s[24:27], s50 offen
.Lk1_qepi:
  s_nop 15
  s_mov_b32 s52, 0x3eb8aa3b
  s_lshl_b32 s50, s45, 2
  s_lshl_b32 s51, s42, 1
  s_add_u32 s50, s50, s51
  s_lshl_b32 s50, s50, 5
  s_lshl_b32 s51, s44, 2
  s_add_u32 s50, s50, s51
  s_lshl_b32 s51, s43, 1
  s_add_u32 s50, s50, s51
  s_lshl_b32 s50, s50, 10
  s_add_u32 s51, s50, 32768
  v_lshlrev_b32 v2, 4, v0
  v_mul_f32 v32, s52, v32
  v_mul_f32 v33, s52, v33
  v_mul_f32 v34, s52, v34
  v_mul_f32 v35, s52, v35
  v_mul_f32 v36, s52, v36
  v_mul_f32 v37, s52, v37
  v_mul_f32 v38, s52, v38
  v_mul_f32 v39, s52, v39
  v_mul_f32 v40, s52, v40
  v_mul_f32 v41, s52, v41
  v_mul_f32 v42, s52, v42
  v_mul_f32 v43, s52, v43
  v_mul_f32 v44, s52, v44
  v_mul_f32 v45, s52, v45
  v_mul_f32 v46, s52, v46
  v_mul_f32 v47, s52, v47
  v_cvt_pk_bf16_f32 v80, v32, v33
  v_cvt_pk_bf16_f32 v81, v34, v35
  v_cvt_pk_bf16_f32 v82, v36, v37
  v_cvt_pk_bf16_f32 v83, v38, v39
  v_cvt_pk_bf16_f32 v84, v40, v41
  v_cvt_pk_bf16_f32 v85, v42, v43
  v_cvt_pk_bf16_f32 v86, v44, v45
  v_cvt_pk_bf16_f32 v87, v46, v47
  buffer_store_dwordx4 v[80:83], v2, s[24:27], s50 offen offset:0
  buffer_store_dwordx4 v[84:87], v2, s[24:27], s50 offen offset:1024
  v_mul_f32 v48, s52, v48
  v_mul_f32 v49, s52, v49
  v_mul_f32 v50, s52, v50
  v_mul_f32 v51, s52, v51
  v_mul_f32 v52, s52, v52
  v_mul_f32 v53, s52, v53
  v_mul_f32 v54, s52, v54
  v_mul_f32 v55, s52, v55
  v_mul_f32 v56, s52, v56
  v_mul_f32 v57, s52, v57
  v_mul_f32 v58, s52, v58
  v_mul_f32 v59, s52, v59
  v_mul_f32 v60, s52, v60
  v_mul_f32 v61, s52, v61
  v_mul_f32 v62, s52, v62
  v_mul_f32 v63, s52, v63
  v_cvt_pk_bf16_f32 v88, v48, v49
  v_cvt_pk_bf16_f32 v89, v50, v51
  v_cvt_pk_bf16_f32 v90, v52, v53
  v_cvt_pk_bf16_f32 v91, v54, v55
  v_cvt_pk_bf16_f32 v92, v56, v57
  v_cvt_pk_bf16_f32 v93, v58, v59
  v_cvt_pk_bf16_f32 v94, v60, v61
  v_cvt_pk_bf16_f32 v95, v62, v63
  buffer_store_dwordx4 v[88:91], v2, s[24:27], s51 offen offset:0
  buffer_store_dwordx4 v[92:95], v2, s[24:27], s51 offen offset:1024
  s_cmp_lg_u32 s3, 1
  s_cbranch_scc1 .Lk1_nofl
  v_mov_b32 v4, 0
  s_lshl_b32 s50, s45, 3
  s_add_u32 s50, s50, s44
  s_lshl_b32 s50, s50, 9
  s_add_u32 s50, s50, 11534336
  v_lshlrev_b32 v3, 3, v0
  v_mov_b32 v5, 0
  buffer_store_dwordx2 v[4:5], v3, s[24:27], s50 offen
.Lk1_nofl:
  s_lshl_b32 s50, s45, 3
  s_add_u32 s50, s50, s44
  s_cmp_ge_u32 s50, 52
  s_cbranch_scc1 .Lk1_notab
  s_cmp_lg_u32 s3, 0
  s_cbranch_scc1 .Lk1_notab
  s_mul_i32 s51, s50, 43
  s_lshr_b32 s51, s51, 9
  s_mul_i32 s52, s51, 12
  s_sub_u32 s52, s50, s52
  s_and_b32 s53, s52, 3
  s_lshr_b32 s52, s52, 2
  s_lshl_b32 s54, s51, 4
  s_and_b32 s60, s53, 1
  s_lshr_b32 s61, s53, 1
  s_cmp_eq_u32 s51, 4
  s_cbranch_scc1 .Lk1_t32
  s_cmp_eq_u32 s52, 0
  s_cbranch_scc0 .Lk1_ttw
  s_lshl_b32 s55, s60, 5
  s_mov_b32 s56, 3
  s_mov_b32 s57, 4
  s_mov_b32 s58, 0x3c800000
  s_mov_b32 s59, s61
  s_mov_b32 s62, 1
  s_branch .Lk1_tgo
.Lk1_t32:
  s_lshl_b32 s54, s60, 4
  s_mov_b32 s55, 0
  s_mov_b32 s56, 2
  s_mov_b32 s57, 16
  s_mov_b32 s58, 0x3d000000
  s_mov_b32 s59, s61
  s_mov_b32 s62, 1
  s_branch .Lk1_tgo
.Lk1_ttw:
  s_lshl_b32 s55, s61, 4
  s_mov_b32 s63, s54
  s_cmp_eq_u32 s52, 2
  s_cselect_b32 s54, s55, s63
  s_cselect_b32 s55, s63, s55
  s_mov_b32 s56, 2
  s_mov_b32 s57, 4
  s_mov_b32 s58, 0x3a000000
  s_mov_b32 s59, s60
  s_mov_b32 s62, 0
.Lk1_tgo:
  s_cmp_eq_u32 s59, 0
  s_cselect_b32 s59, 0, 0xbe800000
  v_and_b32 v2, 15, v0
  v_add_u32 v2, s54, v2
  v_cvt_f32_u32 v2, v2
  v_mul_f32 v2, s58, v2
  v_lshrrev_b32 v3, 4, v0
  v_lshlrev_b32 v3, s56, v3
  v_add_u32 v3, s55, v3
  v_add_u32 v4, s57, v3
  v_mov_b32 v5, s59
  v_add_u32 v20, 0, v3
  v_cvt_f32_u32 v20, v20
  v_fma_f32 v20, v20, v2, v5
  v_cos_f32 v20, v20
  v_add_u32 v21, 1, v3
  v_cvt_f32_u32 v21, v21
  v_fma_f32 v21, v21, v2, v5
  v_cos_f32 v21, v21
  v_add_u32 v22, 2, v3
  v_cvt_f32_u32 v22, v22
  v_fma_f32 v22, v22, v2, v5
  v_cos_f32 v22, v22
  v_add_u32 v23, 3, v3
  v_cvt_f32_u32 v23, v23
  v_fma_f32 v23, v23, v2, v5
  v_cos_f32 v23, v23
  v_add_u32 v24, 0, v4
  v_cvt_f32_u32 v24, v24
  v_fma_f32 v24, v24, v2, v5
  v_cos_f32 v24, v24
  v_add_u32 v25, 1, v4
  v_cvt_f32_u32 v25, v25
  v_fma_f32 v25, v25, v2, v5
  v_cos_f32 v25, v25
  v_add_u32 v26, 2, v4
  v_cvt_f32_u32 v26, v26
  v_fma_f32 v26, v26, v2, v5
  v_cos_f32 v26, v26
  v_add_u32 v27, 3, v4
  v_cvt_f32_u32 v27, v27
  v_fma_f32 v27, v27, v2, v5
  v_cos_f32 v27, v27
  s_cmp_eq_u32 s62, 0
  s_cbranch_scc1 .Lk1_tst
  v_cvt_pk_bf16_f32 v20, v20, v21
  v_cvt_pk_bf16_f32 v21, v22, v23
  v_cvt_pk_bf16_f32 v22, v24, v25
  v_cvt_pk_bf16_f32 v23, v26, v27
.Lk1_tst:
  s_lshl_b32 s50, s50, 10
  s_add_u32 s50, s50, 10485760
  v_lshlrev_b32 v2, 4, v0
  buffer_store_dwordx4 v[20:23], v2, s[24:27], s50 offen sc1
.Lk1_notab:
  s_branch .Lfin_k1_kernel
.Lk1_y:
  s_mov_b32 s28, s14
  s_mov_b32 s29, s15
  s_mov_b32 s30, 2097152
  s_mov_b32 s31, 0x00020000
  s_mov_b32 s32, s16
  s_mov_b32 s33, s17
  s_mov_b32 s34, 1052672
  s_mov_b32 s35, 0x00020000
  s_mov_b32 s36, s18
  s_mov_b32 s37, s19
  s_mov_b32 s38, 1052672
  s_mov_b32 s39, 0x00020000
  s_lshr_b32 s50, s45, 3
  s_and_b32 s51, s45, 7
  s_lshl_b32 s53, s50, 10
  s_lshl_b32 s54, s42, 9
  s_add_u32 s53, s53, s54
  s_lshl_b32 s54, s43, 7
  s_add_u32 s53, s53, s54
  s_lshl_b32 s54, s51, 2
  s_add_u32 s53, s53, s54
  s_lshl_b32 s53, s53, 10
  v_lshlrev_b32 v9, 4, v0
  v_add_u32 v10, s53, v9
  s_lshl_b32 s54, s43, 1
  s_add_u32 s54, s54, s42
  s_mul_i32 s55, s54, 8448
  s_mov_b32 s52, 0
  s_add_u32 m0, s55, 0
  s_nop 0
  buffer_load_dwordx4 v10, s[28:31], s52 offen lds
  s_mov_b32 s52, 32768
  s_add_u32 m0, s55, 1056
  s_nop 0
  buffer_load_dwordx4 v10, s[28:31], s52 offen lds
  s_mov_b32 s52, 65536
  s_add_u32 m0, s55, 2112
  s_nop 0
  buffer_load_dwordx4 v10, s[28:31], s52 offen lds
  s_mov_b32 s52, 98304
  s_add_u32 m0, s55, 3168
  s_nop 0
  buffer_load_dwordx4 v10, s[28:31], s52 offen lds
  s_mov_b32 s52, 262144
  s_add_u32 m0, s55, 4224
  s_nop 0
  buffer_load_dwordx4 v10, s[28:31], s52 offen lds
  s_mov_b32 s52, 294912
  s_add_u32 m0, s55, 5280
  s_nop 0
  buffer_load_dwordx4 v10, s[28:31], s52 offen lds
  s_mov_b32 s52, 327680
  s_add_u32 m0, s55, 6336
  s_nop 0
  buffer_load_dwordx4 v10, s[28:31], s52 offen lds
  s_mov_b32 s52, 360448
  s_add_u32 m0, s55, 7392
  s_nop 0
  buffer_load_dwordx4 v10, s[28:31], s52 offen lds
  s_lshl_b32 s56, s45, 3
  s_add_u32 s56, s56, s44
  s_and_b32 s57, s56, 3
  s_lshr_b32 s56, s56, 2
  s_lshl_b32 s56, s56, 3
  s_mov_b32 s52, 1024
  s_add_u32 m0, s55, 33792
  s_nop 0
  buffer_load_dwordx4 v10, s[28:31], s52 offen lds
  s_lshl_b32 s58, s3, 1
  s_add_u32 s56, s56, s58
  s_lshr_b32 s58, s56, 6
  s_lshl_b32 s58, s58, 4
  s_and_b32 s59, s56, 15
  s_mov_b32 s52, 33792
  s_add_u32 m0, s55, 34848
  s_nop 0
  buffer_load_dwordx4 v10, s[28:31], s52 offen lds
  s_add_u32 s58, s58, s59
  s_bfe_u32 s59, s56, 0x20004
  s_lshl_b32 s59, s59, 8
  s_add_u32 s58, s58, s59
  s_mul_i32 s58, s58, 514
  s_mov_b32 s52, 66560
  s_add_u32 m0, s55, 35904
  s_nop 0
  buffer_load_dwordx4 v10, s[28:31], s52 offen lds
  s_lshl_b32 s59, s57, 7
  s_add_u32 s60, s58, s59
  v_lshlrev_b32 v8, 1, v0
  s_lshl_b32 s61, s56, 5
  s_lshl_b32 s59, s57, 19
  s_mov_b32 s52, 99328
  s_add_u32 m0, s55, 36960
  s_nop 0
  buffer_load_dwordx4 v10, s[28:31], s52 offen lds
  s_add_u32 s62, s61, s59
  s_add_u32 s62, s62, 13107200
  s_add_u32 s61, s61, 15204352
  v_and_b32 v193, 3, v0
  v_bfe_u32 v192, v0, 2, 1
  s_mov_b32 s52, 263168
  s_add_u32 m0, s55, 38016
  s_nop 0
  buffer_load_dwordx4 v10, s[28:31], s52 offen lds
  v_lshl_add_u32 v193, v192, 4, v193
  v_mul_u32_u24 v193, 32896, v193
  v_bfe_u32 v192, v0, 3, 1
  v_mul_u32_u24 v192, 514, v192
  v_add3_u32 v193, v193, v192, s58
  s_mov_b32 s52, 295936
  s_add_u32 m0, s55, 39072
  s_nop 0
  buffer_load_dwordx4 v10, s[28:31], s52 offen lds
  v_add_u32 v193, 512, v193
  s_cmp_eq_u32 s57, 0
  s_cselect_b32 s64, 0xffff, 0
  s_mov_b32 s65, 0
  v_cndmask_b32 v194, -1, v193, s[64:65]
  s_mov_b32 s52, 328704
  s_add_u32 m0, s55, 40128
  s_nop 0
  buffer_load_dwordx4 v10, s[28:31], s52 offen lds
  s_lshl_b32 s56, s44, 6
  s_lshl_b32 s57, s3, 4
  s_add_u32 s56, s56, s57
  v_and_b32 v2, 15, v0
  v_add_u32 v12, s56, v2
  s_mov_b32 s52, 361472
  s_add_u32 m0, s55, 41184
  s_nop 0
  buffer_load_dwordx4 v10, s[28:31], s52 offen lds
  v_lshrrev_b32 v3, 1, v12
  v_and_b32 v4, 1, v12
  v_cmp_eq_u32 vcc, 1, v12
  v_mov_b32 v5, 0x100
  v_and_b32 v6, 1, v3
  s_add_u32 s52, s60, 0
  buffer_load_short_d16 v160, v8, s[32:35], s52 offen
  v_cndmask_b32 v3, v3, v5, vcc
  v_cndmask_b32 v4, v4, 0, vcc
  v_mov_b32 v7, 0x80008000
  v_mul_lo_u32 v7, v7, v6
  v_cvt_f32_u32 v3, v3
  s_add_u32 s52, s60, 0
  buffer_load_short_d16_hi v176, v8, s[36:39], s52 offen
  v_mul_f32 v3, 0x3b000000, v3
  v_cvt_f32_u32 v4, v4
  v_mul_f32 v4, 0x3e800000, v4
  v_lshrrev_b32 v5, 4, v0
  v_lshlrev_b32 v6, 3, v5
  s_add_u32 s52, s60, 32896
  buffer_load_short_d16 v161, v8, s[32:35], s52 offen
  v_cvt_f32_u32 v6, v6
  v_fma_f32 v4, v6, v3, v4
  v_mul_u32_u24 v14, 1056, v2
  v_lshl_add_u32 v14, v5, 4, v14
  v_lshlrev_b32 v12, 12, v12
  s_add_u32 s52, s60, 32896
  buffer_load_short_d16_hi v177, v8, s[36:39], s52 offen
  v_lshl_add_u32 v12, v5, 4, v12
  s_lshl_b32 s50, s50, 11
  s_lshl_b32 s51, s51, 8
  s_add_u32 s50, s50, s51
  s_add_u32 s50, s50, 3145728
  s_add_u32 s52, s60, 65792
  buffer_load_short_d16 v162, v8, s[32:35], s52 offen
  v_fmamk_f32 v20, v3, 0x00000000, v4
  v_fmamk_f32 v21, v3, 0x3f800000, v4
  v_fmamk_f32 v22, v3, 0x40000000, v4
  v_fmamk_f32 v23, v3, 0x40400000, v4
  v_fmamk_f32 v24, v3, 0x40800000, v4
  s_add_u32 s52, s60, 65792
  buffer_load_short_d16_hi v178, v8, s[36:39], s52 offen
  v_fmamk_f32 v25, v3, 0x40a00000, v4
  v_fmamk_f32 v26, v3, 0x40c00000, v4
  v_fmamk_f32 v27, v3, 0x40e00000, v4
  v_cos_f32 v20, v20
  v_cos_f32 v21, v21
  s_add_u32 s52, s60, 98688
  buffer_load_short_d16 v163, v8, s[32:35], s52 offen
  v_cos_f32 v22, v22
  v_cos_f32 v23, v23
  v_cos_f32 v24, v24
  v_cos_f32 v25, v25
  v_cos_f32 v26, v26
  s_add_u32 s52, s60, 98688
  buffer_load_short_d16_hi v179, v8, s[36:39], s52 offen
  v_cos_f32 v27, v27
  v_cvt_pk_bf16_f32 v64, v20, v21
  v_cvt_pk_bf16_f32 v65, v22, v23
  v_cvt_pk_bf16_f32 v66, v24, v25
  v_cvt_pk_bf16_f32 v67, v26, v27
  s_add_u32 s52, s60, 526336
  buffer_load_short_d16 v164, v8, s[32:35], s52 offen
  v_xor_b32 v96, v7, v64
  v_xor_b32 v97, v7, v65
  v_xor_b32 v98, v7, v66
  v_xor_b32 v99, v7, v67
  v_fmamk_f32 v20, v3, 0x42000000, v4
  s_add_u32 s52, s60, 526336
  buffer_load_short_d16_hi v180, v8, s[36:39], s52 offen
  v_fmamk_f32 v21, v3, 0x42040000, v4
  v_fmamk_f32 v22, v3, 0x42080000, v4
  v_fmamk_f32 v23, v3, 0x420c0000, v4
  v_fmamk_f32 v24, v3, 0x42100000, v4
  v_fmamk_f32 v25, v3, 0x42140000, v4
  s_add_u32 s52, s60, 559232
  buffer_load_short_d16 v165, v8, s[32:35], s52 offen
  v_fmamk_f32 v26, v3, 0x42180000, v4
  v_fmamk_f32 v27, v3, 0x421c0000, v4
  v_cos_f32 v20, v20
  v_cos_f32 v21, v21
  v_cos_f32 v22, v22
  s_add_u32 s52, s60, 559232
  buffer_load_short_d16_hi v181, v8, s[36:39], s52 offen
  v_cos_f32 v23, v23
  v_cos_f32 v24, v24
  v_cos_f32 v25, v25
  v_cos_f32 v26, v26
  v_cos_f32 v27, v27
  s_add_u32 s52, s60, 592128
  buffer_load_short_d16 v166, v8, s[32:35], s52 offen
  v_cvt_pk_bf16_f32 v68, v20, v21
  v_cvt_pk_bf16_f32 v69, v22, v23
  v_cvt_pk_bf16_f32 v70, v24, v25
  v_cvt_pk_bf16_f32 v71, v26, v27
  v_xor_b32 v100, v7, v68
  s_add_u32 s52, s60, 592128
  buffer_load_short_d16_hi v182, v8, s[36:39], s52 offen
  v_xor_b32 v101, v7, v69
  v_xor_b32 v102, v7, v70
  v_xor_b32 v103, v7, v71
  v_fmamk_f32 v20, v3, 0x42800000, v4
  v_fmamk_f32 v21, v3, 0x42820000, v4
  s_add_u32 s52, s60, 625024
  buffer_load_short_d16 v167, v8, s[32:35], s52 offen
  v_fmamk_f32 v22, v3, 0x42840000, v4
  v_fmamk_f32 v23, v3, 0x42860000, v4
  v_fmamk_f32 v24, v3, 0x42880000, v4
  v_fmamk_f32 v25, v3, 0x428a0000, v4
  v_fmamk_f32 v26, v3, 0x428c0000, v4
  s_add_u32 s52, s60, 625024
  buffer_load_short_d16_hi v183, v8, s[36:39], s52 offen
  v_fmamk_f32 v27, v3, 0x428e0000, v4
  v_cos_f32 v20, v20
  v_cos_f32 v21, v21
  v_cos_f32 v22, v22
  v_cos_f32 v23, v23
  s_add_u32 s52, s60, 514
  buffer_load_short_d16 v168, v8, s[32:35], s52 offen
  v_cos_f32 v24, v24
  v_cos_f32 v25, v25
  v_cos_f32 v26, v26
  v_cos_f32 v27, v27
  v_cvt_pk_bf16_f32 v72, v20, v21
  s_add_u32 s52, s60, 514
  buffer_load_short_d16_hi v184, v8, s[36:39], s52 offen
  v_cvt_pk_bf16_f32 v73, v22, v23
  v_cvt_pk_bf16_f32 v74, v24, v25
  v_cvt_pk_bf16_f32 v75, v26, v27
  v_xor_b32 v104, v7, v72
  v_xor_b32 v105, v7, v73
  s_add_u32 s52, s60, 33410
  buffer_load_short_d16 v169, v8, s[32:35], s52 offen
  v_xor_b32 v106, v7, v74
  v_xor_b32 v107, v7, v75
  v_fmamk_f32 v20, v3, 0x42c00000, v4
  v_fmamk_f32 v21, v3, 0x42c20000, v4
  v_fmamk_f32 v22, v3, 0x42c40000, v4
  s_add_u32 s52, s60, 33410
  buffer_load_short_d16_hi v185, v8, s[36:39], s52 offen
  v_fmamk_f32 v23, v3, 0x42c60000, v4
  v_fmamk_f32 v24, v3, 0x42c80000, v4
  v_fmamk_f32 v25, v3, 0x42ca0000, v4
  v_fmamk_f32 v26, v3, 0x42cc0000, v4
  v_fmamk_f32 v27, v3, 0x42ce0000, v4
  s_add_u32 s52, s60, 66306
  buffer_load_short_d16 v170, v8, s[32:35], s52 offen
  v_cos_f32 v20, v20
  v_cos_f32 v21, v21
  v_cos_f32 v22, v22
  v_cos_f32 v23, v23
  v_cos_f32 v24, v24
  s_add_u32 s52, s60, 66306
  buffer_load_short_d16_hi v186, v8, s[36:39], s52 offen
  v_cos_f32 v25, v25
  v_cos_f32 v26, v26
  v_cos_f32 v27, v27
  v_cvt_pk_bf16_f32 v76, v20, v21
  v_cvt_pk_bf16_f32 v77, v22, v23
  s_add_u32 s52, s60, 99202
  buffer_load_short_d16 v171, v8, s[32:35], s52 offen
  v_cvt_pk_bf16_f32 v78, v24, v25
  v_cvt_pk_bf16_f32 v79, v26, v27
  v_xor_b32 v108, v7, v76
  v_xor_b32 v109, v7, v77
  v_xor_b32 v110, v7, v78
  s_add_u32 s52, s60, 99202
  buffer_load_short_d16_hi v187, v8, s[36:39], s52 offen
  v_xor_b32 v111, v7, v79
  v_fmamk_f32 v20, v3, 0x43000000, v4
  v_fmamk_f32 v21, v3, 0x43010000, v4
  v_fmamk_f32 v22, v3, 0x43020000, v4
  v_fmamk_f32 v23, v3, 0x43030000, v4
  s_add_u32 s52, s60, 526850
  buffer_load_short_d16 v172, v8, s[32:35], s52 offen
  v_fmamk_f32 v24, v3, 0x43040000, v4
  v_fmamk_f32 v25, v3, 0x43050000, v4
  v_fmamk_f32 v26, v3, 0x43060000, v4
  v_fmamk_f32 v27, v3, 0x43070000, v4
  v_cos_f32 v20, v20
  s_add_u32 s52, s60, 526850
  buffer_load_short_d16_hi v188, v8, s[36:39], s52 offen
  v_cos_f32 v21, v21
  v_cos_f32 v22, v22
  v_cos_f32 v23, v23
  v_cos_f32 v24, v24
  v_cos_f32 v25, v25
  s_add_u32 s52, s60, 559746
  buffer_load_short_d16 v173, v8, s[32:35], s52 offen
  v_cos_f32 v26, v26
  v_cos_f32 v27, v27
  v_cvt_pk_bf16_f32 v80, v20, v21
  v_cvt_pk_bf16_f32 v81, v22, v23
  v_cvt_pk_bf16_f32 v82, v24, v25
  s_add_u32 s52, s60, 559746
  buffer_load_short_d16_hi v189, v8, s[36:39], s52 offen
  v_cvt_pk_bf16_f32 v83, v26, v27
  v_xor_b32 v112, v7, v80
  v_xor_b32 v113, v7, v81
  v_xor_b32 v114, v7, v82
  v_xor_b32 v115, v7, v83
  s_add_u32 s52, s60, 592642
  buffer_load_short_d16 v174, v8, s[32:35], s52 offen
  v_fmamk_f32 v20, v3, 0x43200000, v4
  v_fmamk_f32 v21, v3, 0x43210000, v4
  v_fmamk_f32 v22, v3, 0x43220000, v4
  v_fmamk_f32 v23, v3, 0x43230000, v4
  v_fmamk_f32 v24, v3, 0x43240000, v4
  s_add_u32 s52, s60, 592642
  buffer_load_short_d16_hi v190, v8, s[36:39], s52 offen
  v_fmamk_f32 v25, v3, 0x43250000, v4
  v_fmamk_f32 v26, v3, 0x43260000, v4
  v_fmamk_f32 v27, v3, 0x43270000, v4
  v_cos_f32 v20, v20
  v_cos_f32 v21, v21
  s_add_u32 s52, s60, 625538
  buffer_load_short_d16 v175, v8, s[32:35], s52 offen
  v_cos_f32 v22, v22
  v_cos_f32 v23, v23
  v_cos_f32 v24, v24
  v_cos_f32 v25, v25
  v_cos_f32 v26, v26
  s_add_u32 s52, s60, 625538
  buffer_load_short_d16_hi v191, v8, s[36:39], s52 offen
  v_cos_f32 v27, v27
  v_cvt_pk_bf16_f32 v84, v20, v21
  v_cvt_pk_bf16_f32 v85, v22, v23
  v_cvt_pk_bf16_f32 v86, v24, v25
  v_cvt_pk_bf16_f32 v87, v26, v27
  buffer_load_short_d16 v192, v194, s[32:35], 0 offen
  v_xor_b32 v116, v7, v84
  v_xor_b32 v117, v7, v85
  v_xor_b32 v118, v7, v86
  v_xor_b32 v119, v7, v87
  v_fmamk_f32 v20, v3, 0x43400000, v4
  buffer_load_short_d16_hi v193, v194, s[36:39], 0 offen
  v_fmamk_f32 v21, v3, 0x43410000, v4
  v_fmamk_f32 v22, v3, 0x43420000, v4
  v_fmamk_f32 v23, v3, 0x43430000, v4
  v_fmamk_f32 v24, v3, 0x43440000, v4
  v_fmamk_f32 v25, v3, 0x43450000, v4
  v_fmamk_f32 v26, v3, 0x43460000, v4
  v_fmamk_f32 v27, v3, 0x43470000, v4
  v_cos_f32 v20, v20
  v_cos_f32 v21, v21
  v_cos_f32 v22, v22
  v_cos_f32 v23, v23
  v_cos_f32 v24, v24
  v_cos_f32 v25, v25
  v_cos_f32 v26, v26
  v_cos_f32 v27, v27
  v_cvt_pk_bf16_f32 v88, v20, v21
  v_cvt_pk_bf16_f32 v89, v22, v23
  v_cvt_pk_bf16_f32 v90, v24, v25
  v_cvt_pk_bf16_f32 v91, v26, v27
  v_xor_b32 v120, v7, v88
  v_xor_b32 v121, v7, v89
  v_xor_b32 v122, v7, v90
  v_xor_b32 v123, v7, v91
  v_fmamk_f32 v20, v3, 0x43600000, v4
  v_fmamk_f32 v21, v3, 0x43610000, v4
  v_fmamk_f32 v22, v3, 0x43620000, v4
  v_fmamk_f32 v23, v3, 0x43630000, v4
  v_fmamk_f32 v24, v3, 0x43640000, v4
  v_fmamk_f32 v25, v3, 0x43650000, v4
  v_fmamk_f32 v26, v3, 0x43660000, v4
  v_fmamk_f32 v27, v3, 0x43670000, v4
  v_cos_f32 v20, v20
  v_cos_f32 v21, v21
  v_cos_f32 v22, v22
  v_cos_f32 v23, v23
  v_cos_f32 v24, v24
  v_cos_f32 v25, v25
  v_cos_f32 v26, v26
  v_cos_f32 v27, v27
  v_cvt_pk_bf16_f32 v92, v20, v21
  v_cvt_pk_bf16_f32 v93, v22, v23
  v_cvt_pk_bf16_f32 v94, v24, v25
  v_cvt_pk_bf16_f32 v95, v26, v27
  v_xor_b32 v124, v7, v92
  v_xor_b32 v125, v7, v93
  v_xor_b32 v126, v7, v94
  v_xor_b32 v127, v7, v95
  s_lshl_b32 s56, s45, 3
  s_add_u32 s56, s56, s44
  s_lshl_b32 s56, s56, 2
  s_add_u32 s56, s56, s3
  s_lshr_b32 s57, s56, 5
  s_and_b32 s58, s56, 31
  v_and_b32 v2, 3, v0
  v_bfe_u32 v3, v0, 2, 1
  v_lshl_add_u32 v2, v3, 4, v2
  v_bfe_u32 v3, v0, 3, 2
  v_lshl_add_u32 v2, v3, 2, v2
  s_lshl_b32 s57, s57, 5
  v_add_u32 v2, s57, v2
  v_cvt_f32_u32 v2, v2
  v_mul_f32 v2, 0x3b000000, v2
  v_lshrrev_b32 v3, 5, v0
  v_lshlrev_b32 v3, 2, v3
  s_lshl_b32 s59, s58, 3
  v_add_u32 v3, s59, v3
  v_cmp_eq_u32 vcc, 0, v3
  v_mov_b32 v6, 0x36000000
  v_mov_b32 v7, 0x35800000
  v_cndmask_b32 v7, v6, v7, vcc
  v_add_u32 v4, 0, v3
  v_cvt_f32_u32 v4, v4
  v_mul_f32 v20, v4, v2
  v_add_f32 v21, 0x3e800000, v20
  v_mul_f32 v5, 0x43800000, v2
  v_cndmask_b32 v21, v21, v5, vcc
  v_add_u32 v4, 1, v3
  v_cvt_f32_u32 v4, v4
  v_mul_f32 v22, v4, v2
  v_add_f32 v23, 0x3e800000, v22
  v_add_u32 v4, 2, v3
  v_cvt_f32_u32 v4, v4
  v_mul_f32 v24, v4, v2
  v_add_f32 v25, 0x3e800000, v24
  v_add_u32 v4, 3, v3
  v_cvt_f32_u32 v4, v4
  v_mul_f32 v26, v4, v2
  v_add_f32 v27, 0x3e800000, v26
  v_cos_f32 v20, v20
  v_cos_f32 v21, v21
  v_cos_f32 v22, v22
  v_cos_f32 v23, v23
  v_cos_f32 v24, v24
  v_cos_f32 v25, v25
  v_cos_f32 v26, v26
  v_cos_f32 v27, v27
  v_mul_f32 v20, v7, v20
  v_mul_f32 v21, v7, v21
  v_mul_f32 v22, v6, v22
  v_mul_f32 v23, v6, v23
  v_mul_f32 v24, v6, v24
  v_mul_f32 v25, v6, v25
  v_mul_f32 v26, v6, v26
  v_mul_f32 v27, v6, v27
  v_cvt_pk_bf16_f32 v28, v20, v21
  v_cvt_pk_bf16_f32 v29, v22, v23
  v_cvt_pk_bf16_f32 v30, v24, v25
  v_cvt_pk_bf16_f32 v31, v26, v27
  s_lshl_b32 s56, s56, 10
  s_add_u32 s56, s56, 9437184
  buffer_store_dwordx4 v[28:31], v9, s[24:27], s56 offen sc1
  s_waitcnt vmcnt(43)
  s_barrier
  v_add_u32 v15, 0, v14
  ds_read_b128 v[128:131], v15 offset:0
  ds_read_b128 v[132:135], v15 offset:16896
  ds_read_b128 v[136:139], v15 offset:64
  ds_read_b128 v[140:143], v15 offset:16960
  ds_read_b128 v[144:147], v15 offset:128
  ds_read_b128 v[148:151], v15 offset:17024
  ds_read_b128 v[152:155], v15 offset:192
  ds_read_b128 v[156:159], v15 offset:17088
  s_mov_b32 s52, 2048
  s_add_u32 m0, s55, 67584
  s_nop 0
  buffer_load_dwordx4 v10, s[28:31], s52 offen lds
  s_waitcnt lgkmcnt(6)
  v_mfma_f32_16x16x32_bf16 v[32:35], v[128:131], v[64:67], 0
  v_mfma_f32_16x16x32_bf16 v[36:39], v[132:135], v[64:67], 0
  ds_read_b128 v[128:131], v15 offset:256
  ds_read_b128 v[132:135], v15 offset:17152
  s_waitcnt lgkmcnt(6)
  v_mfma_f32_16x16x32_bf16 v[32:35], v[136:139], v[68:71], v[32:35]
  v_mfma_f32_16x16x32_bf16 v[36:39], v[140:143], v[68:71], v[36:39]
  s_mov_b32 s52, 34816
  s_add_u32 m0, s55, 68640
  s_nop 0
  buffer_load_dwordx4 v10, s[28:31], s52 offen lds
  ds_read_b128 v[136:139], v15 offset:320
  ds_read_b128 v[140:143], v15 offset:17216
  s_waitcnt lgkmcnt(6)
  v_mfma_f32_16x16x32_bf16 v[32:35], v[144:147], v[72:75], v[32:35]
  v_mfma_f32_16x16x32_bf16 v[36:39], v[148:151], v[72:75], v[36:39]
  ds_read_b128 v[144:147], v15 offset:384
  ds_read_b128 v[148:151], v15 offset:17280
  s_waitcnt lgkmcnt(6)
  s_mov_b32 s52, 67584
  s_add_u32 m0, s55, 69696
  s_nop 0
  buffer_load_dwordx4 v10, s[28:31], s52 offen lds
  v_mfma_f32_16x16x32_bf16 v[32:35], v[152:155], v[76:79], v[32:35]
  v_mfma_f32_16x16x32_bf16 v[36:39], v[156:159], v[76:79], v[36:39]
  ds_read_b128 v[152:155], v15 offset:448
  ds_read_b128 v[156:159], v15 offset:17344
  s_waitcnt lgkmcnt(6)
  v_mfma_f32_16x16x32_bf16 v[32:35], v[128:131], v[80:83], v[32:35]
  v_mfma_f32_16x16x32_bf16 v[36:39], v[132:135], v[80:83], v[36:39]
  ds_read_b128 v[128:131], v15 offset:512
  s_mov_b32 s52, 100352
  s_add_u32 m0, s55, 70752
  s_nop 0
  buffer_load_dwordx4 v10, s[28:31], s52 offen lds
  ds_read_b128 v[132:135], v15 offset:17408
  s_waitcnt lgkmcnt(6)
  v_mfma_f32_16x16x32_bf16 v[32:35], v[136:139], v[84:87], v[32:35]
  v_mfma_f32_16x16x32_bf16 v[36:39], v[140:143], v[84:87], v[36:39]
  ds_read_b128 v[136:139], v15 offset:576
  ds_read_b128 v[140:143], v15 offset:17472
  s_waitcnt lgkmcnt(6)
  v_mfma_f32_16x16x32_bf16 v[32:35], v[144:147], v[88:91], v[32:35]
  s_mov_b32 s52, 264192
  s_add_u32 m0, s55, 71808
  s_nop 0
  buffer_load_dwordx4 v10, s[28:31], s52 offen lds
  v_mfma_f32_16x16x32_bf16 v[36:39], v[148:151], v[88:91], v[36:39]
  ds_read_b128 v[144:147], v15 offset:640
  ds_read_b128 v[148:151], v15 offset:17536
  s_waitcnt lgkmcnt(6)
  v_mfma_f32_16x16x32_bf16 v[32:35], v[152:155], v[92:95], v[32:35]
  v_mfma_f32_16x16x32_bf16 v[36:39], v[156:159], v[92:95], v[36:39]
  ds_read_b128 v[152:155], v15 offset:704
  ds_read_b128 v[156:159], v15 offset:17600
  s_mov_b32 s52, 296960
  s_add_u32 m0, s55, 72864
  s_nop 0
  buffer_load_dwordx4 v10, s[28:31], s52 offen lds
  s_waitcnt lgkmcnt(6)
  v_mfma_f32_16x16x32_bf16 v[32:35], v[128:131], v[96:99], v[32:35]
  v_mfma_f32_16x16x32_bf16 v[36:39], v[132:135], v[96:99], v[36:39]
  ds_read_b128 v[128:131], v15 offset:768
  ds_read_b128 v[132:135], v15 offset:17664
  s_waitcnt lgkmcnt(6)
  v_mfma_f32_16x16x32_bf16 v[32:35], v[136:139], v[100:103], v[32:35]
  v_mfma_f32_16x16x32_bf16 v[36:39], v[140:143], v[100:103], v[36:39]
  s_mov_b32 s52, 329728
  s_add_u32 m0, s55, 73920
  s_nop 0
  buffer_load_dwordx4 v10, s[28:31], s52 offen lds
  ds_read_b128 v[136:139], v15 offset:832
  ds_read_b128 v[140:143], v15 offset:17728
  s_waitcnt lgkmcnt(6)
  v_mfma_f32_16x16x32_bf16 v[32:35], v[144:147], v[104:107], v[32:35]
  v_mfma_f32_16x16x32_bf16 v[36:39], v[148:151], v[104:107], v[36:39]
  ds_read_b128 v[144:147], v15 offset:896
  ds_read_b128 v[148:151], v15 offset:17792
  s_waitcnt lgkmcnt(6)
  s_mov_b32 s52, 362496
  s_add_u32 m0, s55, 74976
  s_nop 0
  buffer_load_dwordx4 v10, s[28:31], s52 offen lds
  v_mfma_f32_16x16x32_bf16 v[32:35], v[152:155], v[108:111], v[32:35]
  v_mfma_f32_16x16x32_bf16 v[36:39], v[156:159], v[108:111], v[36:39]
  ds_read_b128 v[152:155], v15 offset:960
  ds_read_b128 v[156:159], v15 offset:17856
  s_waitcnt lgkmcnt(6)
  v_mfma_f32_16x16x32_bf16 v[32:35], v[128:131], v[112:115], v[32:35]
  v_mfma_f32_16x16x32_bf16 v[36:39], v[132:135], v[112:115], v[36:39]
  s_waitcnt lgkmcnt(4)
  v_mfma_f32_16x16x32_bf16 v[32:35], v[136:139], v[116:119], v[32:35]
  v_mfma_f32_16x16x32_bf16 v[36:39], v[140:143], v[116:119], v[36:39]
  s_waitcnt lgkmcnt(2)
  v_mfma_f32_16x16x32_bf16 v[32:35], v[144:147], v[120:123], v[32:35]
  v_mfma_f32_16x16x32_bf16 v[36:39], v[148:151], v[120:123], v[36:39]
  s_waitcnt lgkmcnt(0)
  v_mfma_f32_16x16x32_bf16 v[32:35], v[152:155], v[124:127], v[32:35]
  v_mfma_f32_16x16x32_bf16 v[36:39], v[156:159], v[124:127], v[36:39]
  s_waitcnt vmcnt(43)
  s_barrier
  v_add_u32 v15, 33792, v14
  ds_read_b128 v[128:131], v15 offset:0
  ds_read_b128 v[132:135], v15 offset:16896
  ds_read_b128 v[136:139], v15 offset:64
  ds_read_b128 v[140:143], v15 offset:16960
  ds_read_b128 v[144:147], v15 offset:128
  ds_read_b128 v[148:151], v15 offset:17024
  ds_read_b128 v[152:155], v15 offset:192
  ds_read_b128 v[156:159], v15 offset:17088
  s_mov_b32 s52, 3072
  s_add_u32 m0, s55, 101376
  s_nop 0
  buffer_load_dwordx4 v10, s[28:31], s52 offen lds
  s_waitcnt lgkmcnt(6)
  v_mfma_f32_16x16x32_bf16 v[40:43], v[128:131], v[64:67], 0
  v_mfma_f32_16x16x32_bf16 v[44:47], v[132:135], v[64:67], 0
  ds_read_b128 v[128:131], v15 offset:256
  ds_read_b128 v[132:135], v15 offset:17152
  s_waitcnt lgkmcnt(6)
  v_mfma_f32_16x16x32_bf16 v[40:43], v[136:139], v[68:71], v[40:43]
  v_mfma_f32_16x16x32_bf16 v[44:47], v[140:143], v[68:71], v[44:47]
  s_mov_b32 s52, 35840
  s_add_u32 m0, s55, 102432
  s_nop 0
  buffer_load_dwordx4 v10, s[28:31], s52 offen lds
  ds_read_b128 v[136:139], v15 offset:320
  ds_read_b128 v[140:143], v15 offset:17216
  s_waitcnt lgkmcnt(6)
  v_mfma_f32_16x16x32_bf16 v[40:43], v[144:147], v[72:75], v[40:43]
  v_mfma_f32_16x16x32_bf16 v[44:47], v[148:151], v[72:75], v[44:47]
  ds_read_b128 v[144:147], v15 offset:384
  ds_read_b128 v[148:151], v15 offset:17280
  s_waitcnt lgkmcnt(6)
  s_mov_b32 s52, 68608
  s_add_u32 m0, s55, 103488
  s_nop 0
  buffer_load_dwordx4 v10, s[28:31], s52 offen lds
  v_mfma_f32_16x16x32_bf16 v[40:43], v[152:155], v[76:79], v[40:43]
  v_mfma_f32_16x16x32_bf16 v[44:47], v[156:159], v[76:79], v[44:47]
  ds_read_b128 v[152:155], v15 offset:448
  ds_read_b128 v[156:159], v15 offset:17344
  s_waitcnt lgkmcnt(6)
  v_mfma_f32_16x16x32_bf16 v[40:43], v[128:131], v[80:83], v[40:43]
  v_mfma_f32_16x16x32_bf16 v[44:47], v[132:135], v[80:83], v[44:47]
  ds_read_b128 v[128:131], v15 offset:512
  s_mov_b32 s52, 101376
  s_add_u32 m0, s55, 104544
  s_nop 0
  buffer_load_dwordx4 v10, s[28:31], s52 offen lds
  ds_read_b128 v[132:135], v15 offset:17408
  s_waitcnt lgkmcnt(6)
  v_mfma_f32_16x16x32_bf16 v[40:43], v[136:139], v[84:87], v[40:43]
  v_mfma_f32_16x16x32_bf16 v[44:47], v[140:143], v[84:87], v[44:47]
  ds_read_b128 v[136:139], v15 offset:576
  ds_read_b128 v[140:143], v15 offset:17472
  s_waitcnt lgkmcnt(6)
  v_mfma_f32_16x16x32_bf16 v[40:43], v[144:147], v[88:91], v[40:43]
  s_mov_b32 s52, 265216
  s_add_u32 m0, s55, 105600
  s_nop 0
  buffer_load_dwordx4 v10, s[28:31], s52 offen lds
  v_mfma_f32_16x16x32_bf16 v[44:47], v[148:151], v[88:91], v[44:47]
  ds_read_b128 v[144:147], v15 offset:640
  ds_read_b128 v[148:151], v15 offset:17536
  s_waitcnt lgkmcnt(6)
  v_mfma_f32_16x16x32_bf16 v[40:43], v[152:155], v[92:95], v[40:43]
  v_mfma_f32_16x16x32_bf16 v[44:47], v[156:159], v[92:95], v[44:47]
  ds_read_b128 v[152:155], v15 offset:704
  ds_read_b128 v[156:159], v15 offset:17600
  s_mov_b32 s52, 297984
  s_add_u32 m0, s55, 106656
  s_nop 0
  buffer_load_dwordx4 v10, s[28:31], s52 offen lds
  s_waitcnt lgkmcnt(6)
  v_mfma_f32_16x16x32_bf16 v[40:43], v[128:131], v[96:99], v[40:43]
  v_mfma_f32_16x16x32_bf16 v[44:47], v[132:135], v[96:99], v[44:47]
  ds_read_b128 v[128:131], v15 offset:768
  ds_read_b128 v[132:135], v15 offset:17664
  s_waitcnt lgkmcnt(6)
  v_mfma_f32_16x16x32_bf16 v[40:43], v[136:139], v[100:103], v[40:43]
  v_mfma_f32_16x16x32_bf16 v[44:47], v[140:143], v[100:103], v[44:47]
  s_mov_b32 s52, 330752
  s_add_u32 m0, s55, 107712
  s_nop 0
  buffer_load_dwordx4 v10, s[28:31], s52 offen lds
  ds_read_b128 v[136:139], v15 offset:832
  ds_read_b128 v[140:143], v15 offset:17728
  s_waitcnt lgkmcnt(6)
  v_mfma_f32_16x16x32_bf16 v[40:43], v[144:147], v[104:107], v[40:43]
  v_mfma_f32_16x16x32_bf16 v[44:47], v[148:151], v[104:107], v[44:47]
  ds_read_b128 v[144:147], v15 offset:896
  ds_read_b128 v[148:151], v15 offset:17792
  s_waitcnt lgkmcnt(6)
  s_mov_b32 s52, 363520
  s_add_u32 m0, s55, 108768
  s_nop 0
  buffer_load_dwordx4 v10, s[28:31], s52 offen lds
  v_mfma_f32_16x16x32_bf16 v[40:43], v[152:155], v[108:111], v[40:43]
  v_mfma_f32_16x16x32_bf16 v[44:47], v[156:159], v[108:111], v[44:47]
  ds_read_b128 v[152:155], v15 offset:960
  ds_read_b128 v[156:159], v15 offset:17856
  s_waitcnt lgkmcnt(6)
  v_mfma_f32_16x16x32_bf16 v[40:43], v[128:131], v[112:115], v[40:43]
  v_mfma_f32_16x16x32_bf16 v[44:47], v[132:135], v[112:115], v[44:47]
  s_waitcnt lgkmcnt(4)
  v_mfma_f32_16x16x32_bf16 v[40:43], v[136:139], v[116:119], v[40:43]
  v_mfma_f32_16x16x32_bf16 v[44:47], v[140:143], v[116:119], v[44:47]
  s_waitcnt lgkmcnt(2)
  v_mfma_f32_16x16x32_bf16 v[40:43], v[144:147], v[120:123], v[40:43]
  v_mfma_f32_16x16x32_bf16 v[44:47], v[148:151], v[120:123], v[44:47]
  s_waitcnt lgkmcnt(0)
  v_mfma_f32_16x16x32_bf16 v[40:43], v[152:155], v[124:127], v[40:43]
  v_mfma_f32_16x16x32_bf16 v[44:47], v[156:159], v[124:127], v[44:47]
  s_waitcnt vmcnt(17)
  s_mov_b32 s53, 0xffff
  v_lshrrev_b32 v8, 2, v0
  v_lshlrev_b32 v8, 15, v8
  v_and_b32 v2, 3, v0
  v_lshl_add_u32 v8, v2, 4, v8
  v_lshlrev_b32 v2, 2, v0
  v_cndmask_b32 v2, -4, v2, s[64:65]
  v_bfi_b32 v160, s53, v160, v176
  v_bfi_b32 v161, s53, v161, v177
  v_bfi_b32 v162, s53, v162, v178
  v_bfi_b32 v163, s53, v163, v179
  v_bfi_b32 v164, s53, v164, v180
  v_bfi_b32 v165, s53, v165, v181
  v_bfi_b32 v166, s53, v166, v182
  v_bfi_b32 v167, s53, v167, v183
  v_bfi_b32 v168, s53, v168, v184
  v_bfi_b32 v169, s53, v169, v185
  v_bfi_b32 v170, s53, v170, v186
  v_bfi_b32 v171, s53, v171, v187
  v_bfi_b32 v172, s53, v172, v188
  v_bfi_b32 v173, s53, v173, v189
  v_bfi_b32 v174, s53, v174, v190
  v_bfi_b32 v175, s53, v175, v191
  v_bfi_b32 v192, s53, v192, v193
  s_mov_b32 vcc_lo, 0x55555555
  s_mov_b32 vcc_hi, 0x55555555
  s_nop 1
  v_cndmask_b32_dpp v176, v164, v160, vcc quad_perm:[1,0,3,2] row_mask:0xf bank_mask:0xf
  v_cndmask_b32_dpp v177, v165, v161, vcc quad_perm:[1,0,3,2] row_mask:0xf bank_mask:0xf
  v_cndmask_b32_dpp v178, v166, v162, vcc quad_perm:[1,0,3,2] row_mask:0xf bank_mask:0xf
  v_cndmask_b32_dpp v179, v167, v163, vcc quad_perm:[1,0,3,2] row_mask:0xf bank_mask:0xf
  v_cndmask_b32_dpp v184, v172, v168, vcc quad_perm:[1,0,3,2] row_mask:0xf bank_mask:0xf
  v_cndmask_b32_dpp v185, v173, v169, vcc quad_perm:[1,0,3,2] row_mask:0xf bank_mask:0xf
  v_cndmask_b32_dpp v186, v174, v170, vcc quad_perm:[1,0,3,2] row_mask:0xf bank_mask:0xf
  v_cndmask_b32_dpp v187, v175, v171, vcc quad_perm:[1,0,3,2] row_mask:0xf bank_mask:0xf
  s_mov_b32 vcc_lo, 0xaaaaaaaa
  s_mov_b32 vcc_hi, 0xaaaaaaaa
  s_nop 1
  v_cndmask_b32_dpp v180, v160, v164, vcc quad_perm:[1,0,3,2] row_mask:0xf bank_mask:0xf
  v_cndmask_b32_dpp v181, v161, v165, vcc quad_perm:[1,0,3,2] row_mask:0xf bank_mask:0xf
  v_cndmask_b32_dpp v182, v162, v166, vcc quad_perm:[1,0,3,2] row_mask:0xf bank_mask:0xf
  v_cndmask_b32_dpp v183, v163, v167, vcc quad_perm:[1,0,3,2] row_mask:0xf bank_mask:0xf
  v_cndmask_b32_dpp v188, v168, v172, vcc quad_perm:[1,0,3,2] row_mask:0xf bank_mask:0xf
  v_cndmask_b32_dpp v189, v169, v173, vcc quad_perm:[1,0,3,2] row_mask:0xf bank_mask:0xf
  v_cndmask_b32_dpp v190, v170, v174, vcc quad_perm:[1,0,3,2] row_mask:0xf bank_mask:0xf
  v_cndmask_b32_dpp v191, v171, v175, vcc quad_perm:[1,0,3,2] row_mask:0xf bank_mask:0xf
  s_mov_b32 vcc_lo, 0x33333333
  s_mov_b32 vcc_hi, 0x33333333
  s_nop 1
  v_cndmask_b32_dpp v160, v184, v176, vcc quad_perm:[2,3,0,1] row_mask:0xf bank_mask:0xf
  v_cndmask_b32_dpp v161, v185, v177, vcc quad_perm:[2,3,0,1] row_mask:0xf bank_mask:0xf
  v_cndmask_b32_dpp v162, v186, v178, vcc quad_perm:[2,3,0,1] row_mask:0xf bank_mask:0xf
  v_cndmask_b32_dpp v163, v187, v179, vcc quad_perm:[2,3,0,1] row_mask:0xf bank_mask:0xf
  v_cndmask_b32_dpp v164, v188, v180, vcc quad_perm:[2,3,0,1] row_mask:0xf bank_mask:0xf
  v_cndmask_b32_dpp v165, v189, v181, vcc quad_perm:[2,3,0,1] row_mask:0xf bank_mask:0xf
  v_cndmask_b32_dpp v166, v190, v182, vcc quad_perm:[2,3,0,1] row_mask:0xf bank_mask:0xf
  v_cndmask_b32_dpp v167, v191, v183, vcc quad_perm:[2,3,0,1] row_mask:0xf bank_mask:0xf
  s_mov_b32 vcc_lo, 0xcccccccc
  s_mov_b32 vcc_hi, 0xcccccccc
  s_nop 1
  v_cndmask_b32_dpp v168, v176, v184, vcc quad_perm:[2,3,0,1] row_mask:0xf bank_mask:0xf
  v_cndmask_b32_dpp v169, v177, v185, vcc quad_perm:[2,3,0,1] row_mask:0xf bank_mask:0xf
  v_cndmask_b32_dpp v170, v178, v186, vcc quad_perm:[2,3,0,1] row_mask:0xf bank_mask:0xf
  v_cndmask_b32_dpp v171, v179, v187, vcc quad_perm:[2,3,0,1] row_mask:0xf bank_mask:0xf
  v_cndmask_b32_dpp v172, v180, v188, vcc quad_perm:[2,3,0,1] row_mask:0xf bank_mask:0xf
  v_cndmask_b32_dpp v173, v181, v189, vcc quad_perm:[2,3,0,1] row_mask:0xf bank_mask:0xf
  v_cndmask_b32_dpp v174, v182, v190, vcc quad_perm:[2,3,0,1] row_mask:0xf bank_mask:0xf
  v_cndmask_b32_dpp v175, v183, v191, vcc quad_perm:[2,3,0,1] row_mask:0xf bank_mask:0xf
  s_add_u32 s52, s62, 0
  buffer_store_dwordx4 v[160:163], v8, s[24:27], s52 offen sc1
  s_add_u32 s52, s62, 8192
  buffer_store_dwordx4 v[164:167], v8, s[24:27], s52 offen sc1
  s_add_u32 s52, s62, 16384
  buffer_store_dwordx4 v[168:171], v8, s[24:27], s52 offen sc1
  s_add_u32 s52, s62, 24576
  buffer_store_dwordx4 v[172:175], v8, s[24:27], s52 offen sc1
  buffer_store_dword v192, v2, s[24:27], s61 offen sc1
  v_cvt_pk_bf16_f32 v20, v32, v33
  v_cvt_pk_bf16_f32 v21, v34, v35
  v_cvt_pk_bf16_f32 v22, v36, v37
  v_cvt_pk_bf16_f32 v23, v38, v39
  buffer_store_dwordx4 v[20:23], v12, s[24:27], s50 offen offset:0
  s_waitcnt vmcnt(14)
  s_barrier
  v_add_u32 v15, 67584, v14
  ds_read_b128 v[128:131], v15 offset:0
  ds_read_b128 v[132:135], v15 offset:16896
  ds_read_b128 v[136:139], v15 offset:64
  ds_read_b128 v[140:143], v15 offset:16960
  ds_read_b128 v[144:147], v15 offset:128
  ds_read_b128 v[148:151], v15 offset:17024
  ds_read_b128 v[152:155], v15 offset:192
  ds_read_b128 v[156:159], v15 offset:17088
  s_waitcnt lgkmcnt(6)
  v_mfma_f32_16x16x32_bf16 v[48:51], v[128:131], v[64:67], 0
  v_mfma_f32_16x16x32_bf16 v[52:55], v[132:135], v[64:67], 0
  ds_read_b128 v[128:131], v15 offset:256
  ds_read_b128 v[132:135], v15 offset:17152
  s_waitcnt lgkmcnt(6)
  v_mfma_f32_16x16x32_bf16 v[48:51], v[136:139], v[68:71], v[48:51]
  v_mfma_f32_16x16x32_bf16 v[52:55], v[140:143], v[68:71], v[52:55]
  ds_read_b128 v[136:139], v15 offset:320
  ds_read_b128 v[140:143], v15 offset:17216
  s_waitcnt lgkmcnt(6)
  v_mfma_f32_16x16x32_bf16 v[48:51], v[144:147], v[72:75], v[48:51]
  v_mfma_f32_16x16x32_bf16 v[52:55], v[148:151], v[72:75], v[52:55]
  ds_read_b128 v[144:147], v15 offset:384
  ds_read_b128 v[148:151], v15 offset:17280
  s_waitcnt lgkmcnt(6)
  v_mfma_f32_16x16x32_bf16 v[48:51], v[152:155], v[76:79], v[48:51]
  v_mfma_f32_16x16x32_bf16 v[52:55], v[156:159], v[76:79], v[52:55]
  ds_read_b128 v[152:155], v15 offset:448
  ds_read_b128 v[156:159], v15 offset:17344
  s_waitcnt lgkmcnt(6)
  v_mfma_f32_16x16x32_bf16 v[48:51], v[128:131], v[80:83], v[48:51]
  v_mfma_f32_16x16x32_bf16 v[52:55], v[132:135], v[80:83], v[52:55]
  ds_read_b128 v[128:131], v15 offset:512
  ds_read_b128 v[132:135], v15 offset:17408
  s_waitcnt lgkmcnt(6)
  v_mfma_f32_16x16x32_bf16 v[48:51], v[136:139], v[84:87], v[48:51]
  v_mfma_f32_16x16x32_bf16 v[52:55], v[140:143], v[84:87], v[52:55]
  ds_read_b128 v[136:139], v15 offset:576
  ds_read_b128 v[140:143], v15 offset:17472
  s_waitcnt lgkmcnt(6)
  v_mfma_f32_16x16x32_bf16 v[48:51], v[144:147], v[88:91], v[48:51]
  v_mfma_f32_16x16x32_bf16 v[52:55], v[148:151], v[88:91], v[52:55]
  ds_read_b128 v[144:147], v15 offset:640
  ds_read_b128 v[148:151], v15 offset:17536
  s_waitcnt lgkmcnt(6)
  v_mfma_f32_16x16x32_bf16 v[48:51], v[152:155], v[92:95], v[48:51]
  v_mfma_f32_16x16x32_bf16 v[52:55], v[156:159], v[92:95], v[52:55]
  ds_read_b128 v[152:155], v15 offset:704
  ds_read_b128 v[156:159], v15 offset:17600
  s_waitcnt lgkmcnt(6)
  v_mfma_f32_16x16x32_bf16 v[48:51], v[128:131], v[96:99], v[48:51]
  v_mfma_f32_16x16x32_bf16 v[52:55], v[132:135], v[96:99], v[52:55]
  ds_read_b128 v[128:131], v15 offset:768
  ds_read_b128 v[132:135], v15 offset:17664
  s_waitcnt lgkmcnt(6)
  v_mfma_f32_16x16x32_bf16 v[48:51], v[136:139], v[100:103], v[48:51]
  v_mfma_f32_16x16x32_bf16 v[52:55], v[140:143], v[100:103], v[52:55]
  ds_read_b128 v[136:139], v15 offset:832
  ds_read_b128 v[140:143], v15 offset:17728
  s_waitcnt lgkmcnt(6)
  v_mfma_f32_16x16x32_bf16 v[48:51], v[144:147], v[104:107], v[48:51]
  v_mfma_f32_16x16x32_bf16 v[52:55], v[148:151], v[104:107], v[52:55]
  ds_read_b128 v[144:147], v15 offset:896
  ds_read_b128 v[148:151], v15 offset:17792
  s_waitcnt lgkmcnt(6)
  v_mfma_f32_16x16x32_bf16 v[48:51], v[152:155], v[108:111], v[48:51]
  v_mfma_f32_16x16x32_bf16 v[52:55], v[156:159], v[108:111], v[52:55]
  ds_read_b128 v[152:155], v15 offset:960
  ds_read_b128 v[156:159], v15 offset:17856
  s_waitcnt lgkmcnt(6)
  v_mfma_f32_16x16x32_bf16 v[48:51], v[128:131], v[112:115], v[48:51]
  v_mfma_f32_16x16x32_bf16 v[52:55], v[132:135], v[112:115], v[52:55]
  s_waitcnt lgkmcnt(4)
  v_mfma_f32_16x16x32_bf16 v[48:51], v[136:139], v[116:119], v[48:51]
  v_mfma_f32_16x16x32_bf16 v[52:55], v[140:143], v[116:119], v[52:55]
  s_waitcnt lgkmcnt(2)
  v_mfma_f32_16x16x32_bf16 v[48:51], v[144:147], v[120:123], v[48:51]
  v_mfma_f32_16x16x32_bf16 v[52:55], v[148:151], v[120:123], v[52:55]
  s_waitcnt lgkmcnt(0)
  v_mfma_f32_16x16x32_bf16 v[48:51], v[152:155], v[124:127], v[48:51]
  v_mfma_f32_16x16x32_bf16 v[52:55], v[156:159], v[124:127], v[52:55]
  v_cvt_pk_bf16_f32 v20, v40, v41
  v_cvt_pk_bf16_f32 v21, v42, v43
  v_cvt_pk_bf16_f32 v22, v44, v45
  v_cvt_pk_bf16_f32 v23, v46, v47
  buffer_store_dwordx4 v[20:23], v12, s[24:27], s50 offen offset:64
  s_waitcnt vmcnt(7)
  s_barrier
  v_add_u32 v15, 101376, v14
  ds_read_b128 v[128:131], v15 offset:0
  ds_read_b128 v[132:135], v15 offset:16896
  ds_read_b128 v[136:139], v15 offset:64
  ds_read_b128 v[140:143], v15 offset:16960
  ds_read_b128 v[144:147], v15 offset:128
  ds_read_b128 v[148:151], v15 offset:17024
  ds_read_b128 v[152:155], v15 offset:192
  ds_read_b128 v[156:159], v15 offset:17088
  s_waitcnt lgkmcnt(6)
  v_mfma_f32_16x16x32_bf16 v[56:59], v[128:131], v[64:67], 0
  v_mfma_f32_16x16x32_bf16 v[60:63], v[132:135], v[64:67], 0
  ds_read_b128 v[128:131], v15 offset:256
  ds_read_b128 v[132:135], v15 offset:17152
  s_waitcnt lgkmcnt(6)
  v_mfma_f32_16x16x32_bf16 v[56:59], v[136:139], v[68:71], v[56:59]
  v_mfma_f32_16x16x32_bf16 v[60:63], v[140:143], v[68:71], v[60:63]
  ds_read_b128 v[136:139], v15 offset:320
  ds_read_b128 v[140:143], v15 offset:17216
  s_waitcnt lgkmcnt(6)
  v_mfma_f32_16x16x32_bf16 v[56:59], v[144:147], v[72:75], v[56:59]
  v_mfma_f32_16x16x32_bf16 v[60:63], v[148:151], v[72:75], v[60:63]
  ds_read_b128 v[144:147], v15 offset:384
  ds_read_b128 v[148:151], v15 offset:17280
  s_waitcnt lgkmcnt(6)
  v_mfma_f32_16x16x32_bf16 v[56:59], v[152:155], v[76:79], v[56:59]
  v_mfma_f32_16x16x32_bf16 v[60:63], v[156:159], v[76:79], v[60:63]
  ds_read_b128 v[152:155], v15 offset:448
  ds_read_b128 v[156:159], v15 offset:17344
  s_waitcnt lgkmcnt(6)
  v_mfma_f32_16x16x32_bf16 v[56:59], v[128:131], v[80:83], v[56:59]
  v_mfma_f32_16x16x32_bf16 v[60:63], v[132:135], v[80:83], v[60:63]
  ds_read_b128 v[128:131], v15 offset:512
  ds_read_b128 v[132:135], v15 offset:17408
  s_waitcnt lgkmcnt(6)
  v_mfma_f32_16x16x32_bf16 v[56:59], v[136:139], v[84:87], v[56:59]
  v_mfma_f32_16x16x32_bf16 v[60:63], v[140:143], v[84:87], v[60:63]
  ds_read_b128 v[136:139], v15 offset:576
  ds_read_b128 v[140:143], v15 offset:17472
  s_waitcnt lgkmcnt(6)
  v_mfma_f32_16x16x32_bf16 v[56:59], v[144:147], v[88:91], v[56:59]
  v_mfma_f32_16x16x32_bf16 v[60:63], v[148:151], v[88:91], v[60:63]
  ds_read_b128 v[144:147], v15 offset:640
  ds_read_b128 v[148:151], v15 offset:17536
  s_waitcnt lgkmcnt(6)
  v_mfma_f32_16x16x32_bf16 v[56:59], v[152:155], v[92:95], v[56:59]
  v_mfma_f32_16x16x32_bf16 v[60:63], v[156:159], v[92:95], v[60:63]
  ds_read_b128 v[152:155], v15 offset:704
  ds_read_b128 v[156:159], v15 offset:17600
  s_waitcnt lgkmcnt(6)
  v_mfma_f32_16x16x32_bf16 v[56:59], v[128:131], v[96:99], v[56:59]
  v_mfma_f32_16x16x32_bf16 v[60:63], v[132:135], v[96:99], v[60:63]
  ds_read_b128 v[128:131], v15 offset:768
  ds_read_b128 v[132:135], v15 offset:17664
  s_waitcnt lgkmcnt(6)
  v_mfma_f32_16x16x32_bf16 v[56:59], v[136:139], v[100:103], v[56:59]
  v_mfma_f32_16x16x32_bf16 v[60:63], v[140:143], v[100:103], v[60:63]
  ds_read_b128 v[136:139], v15 offset:832
  ds_read_b128 v[140:143], v15 offset:17728
  s_waitcnt lgkmcnt(6)
  v_mfma_f32_16x16x32_bf16 v[56:59], v[144:147], v[104:107], v[56:59]
  v_mfma_f32_16x16x32_bf16 v[60:63], v[148:151], v[104:107], v[60:63]
  ds_read_b128 v[144:147], v15 offset:896
  ds_read_b128 v[148:151], v15 offset:17792
  s_waitcnt lgkmcnt(6)
  v_mfma_f32_16x16x32_bf16 v[56:59], v[152:155], v[108:111], v[56:59]
  v_mfma_f32_16x16x32_bf16 v[60:63], v[156:159], v[108:111], v[60:63]
  ds_read_b128 v[152:155], v15 offset:960
  ds_read_b128 v[156:159], v15 offset:17856
  s_waitcnt lgkmcnt(6)
  v_mfma_f32_16x16x32_bf16 v[56:59], v[128:131], v[112:115], v[56:59]
  v_mfma_f32_16x16x32_bf16 v[60:63], v[132:135], v[112:115], v[60:63]
  s_waitcnt lgkmcnt(4)
  v_mfma_f32_16x16x32_bf16 v[56:59], v[136:139], v[116:119], v[56:59]
  v_mfma_f32_16x16x32_bf16 v[60:63], v[140:143], v[116:119], v[60:63]
  s_waitcnt lgkmcnt(2)
  v_mfma_f32_16x16x32_bf16 v[56:59], v[144:147], v[120:123], v[56:59]
  v_mfma_f32_16x16x32_bf16 v[60:63], v[148:151], v[120:123], v[60:63]
  s_waitcnt lgkmcnt(0)
  v_mfma_f32_16x16x32_bf16 v[56:59], v[152:155], v[124:127], v[56:59]
  v_mfma_f32_16x16x32_bf16 v[60:63], v[156:159], v[124:127], v[60:63]
  v_cvt_pk_bf16_f32 v20, v48, v49
  v_cvt_pk_bf16_f32 v21, v50, v51
  v_cvt_pk_bf16_f32 v22, v52, v53
  v_cvt_pk_bf16_f32 v23, v54, v55
  buffer_store_dwordx4 v[20:23], v12, s[24:27], s50 offen offset:128
  s_nop 7
  v_cvt_pk_bf16_f32 v24, v56, v57
  v_cvt_pk_bf16_f32 v25, v58, v59
  v_cvt_pk_bf16_f32 v26, v60, v61
  v_cvt_pk_bf16_f32 v27, v62, v63
  buffer_store_dwordx4 v[24:27], v12, s[24:27], s50 offen offset:192
.Lfin_k1_kernel:
.Lend_k1_kernel:
  s_endpgm
  .p2align 8
  .globl k2_kernel
  .type k2_kernel,@function
k2_kernel:
  s_cmp_ge_u32 s2, 256
  s_cbranch_scc1 .Lend_k2_kernel
  s_load_dwordx16 s[4:19], s[0:1], 0
  s_load_dwordx2 s[20:21], s[0:1], 64
  s_load_dwordx2 s[22:23], s[0:1], 80
  v_lshrrev_b32 v1, 6, v0
  v_and_b32 v0, 63, v0
  v_readfirstlane_b32 s3, v1
  s_and_b32 s40, s2, 7
  s_lshr_b32 s41, s2, 3
  s_waitcnt lgkmcnt(0)
  s_mov_b32 s24, s22
  s_mov_b32 s25, s23
  s_mov_b32 s26, 19922944
  s_mov_b32 s27, 0x00020000
  s_lshl_b32 s44, s40, 8
  s_lshl_b32 s45, s41, 3
  s_add_u32 s44, s44, s45
  s_add_u32 s44, s44, s3
  s_lshl_b32 s44, s44, 10
  v_lshlrev_b32 v1, 4, v0
  s_mov_b32 s46, 0xffff
  s_mov_b32 s47, 0xffff
  s_mov_b32 s48, 0
  s_mov_b32 s49, -1
  buffer_load_dwordx4 v[12:15], v1, s[24:27], s44 offen
  s_and_b32 s68, s3, 3
  s_lshl_b32 s68, s68, 10
  s_cmp_lt_u32 s3, 4
  s_cbranch_scc1 .Lk2_fft
  s_setprio 3
  s_add_u32 s69, s68, 2097152
  s_add_u32 m0, s68, 0
  s_nop 0
  buffer_load_dwordx4 v1, s[24:27], s69 offen lds
  s_add_u32 s69, s68, 2162688
  s_add_u32 m0, s68, 65536
  s_nop 0
  buffer_load_dwordx4 v1, s[24:27], s69 offen lds
  s_add_u32 s69, s68, 2101248
  s_add_u32 m0, s68, 4096
  s_nop 0
  buffer_load_dwordx4 v1, s[24:27], s69 offen lds
  s_add_u32 s69, s68, 2166784
  s_add_u32 m0, s68, 69632
  s_nop 0
  buffer_load_dwordx4 v1, s[24:27], s69 offen lds
  s_add_u32 s69, s68, 2105344
  s_add_u32 m0, s68, 8192
  s_nop 0
  buffer_load_dwordx4 v1, s[24:27], s69 offen lds
  s_add_u32 s69, s68, 2170880
  s_add_u32 m0, s68, 73728
  s_nop 0
  buffer_load_dwordx4 v1, s[24:27], s69 offen lds
  s_add_u32 s69, s68, 2109440
  s_add_u32 m0, s68, 12288
  s_nop 0
  buffer_load_dwordx4 v1, s[24:27], s69 offen lds
  s_add_u32 s69, s68, 2174976
  s_add_u32 m0, s68, 77824
  s_nop 0
  buffer_load_dwordx4 v1, s[24:27], s69 offen lds
  s_mov_b32 s49, 3
  s_cmp_eq_u32 s2, 0
  s_cselect_b32 s70, 7, -1
  s_mov_b32 s67, 12
  s_waitcnt vmcnt(0)
  s_barrier
  s_setprio 1
  s_branch .Lk2_att
.Lk2_fft:
  s_mov_b32 s67, 2
  s_mov_b32 s60, s3
  s_lshl_b32 s61, s40, 5
  s_add_u32 s61, s61, s41
  s_lshl_b32 s51, s61, 13
  s_add_u32 s62, s51, 3145728
  s_add_u32 s63, s51, 3149824
  s_mul_i32 s51, s61, 8704
  s_add_u32 s64, s51, 16777216
  s_add_u32 s65, s51, 16781568
  s_cmp_eq_u32 s2, 0
  s_cselect_b32 s63, 19922944, s63
  s_cselect_b32 s65, 19922944, s65
  v_and_b32 v2, 15, v0
  v_lshrrev_b32 v3, 4, v0
  v_lshlrev_b32 v5, 6, v2
  v_lshl_add_u32 v5, v3, 4, v5
  s_mul_i32 s50, s60, 12288
  s_add_u32 s50, s50, 10485760
  s_add_u32 s51, s50, 4096
  s_add_u32 s52, s50, 8192
  s_mov_b32 s53, 10534912
  s_lshl_b32 s54, s60, 4
  v_add_u32 v7, s54, v2
  v_lshlrev_b32 v8, 5, v0
  s_lshl_b32 s55, s61, 13
  s_lshl_b32 s56, s60, 11
  s_add_u32 s55, s55, s56
  s_add_u32 s56, s55, 13107200
  buffer_load_dwordx4 v[16:19], v5, s[24:27], s62 offen offset:0
  buffer_load_dwordx4 v[20:23], v5, s[24:27], s62 offen offset:2048
  buffer_load_dwordx4 v[24:27], v5, s[24:27], s62 offen offset:1024
  buffer_load_dwordx4 v[28:31], v5, s[24:27], s62 offen offset:3072
  buffer_load_dwordx4 v[32:35], v5, s[24:27], s63 offen offset:0
  buffer_load_dwordx4 v[36:39], v5, s[24:27], s63 offen offset:2048
  buffer_load_dwordx4 v[40:43], v5, s[24:27], s63 offen offset:1024
  buffer_load_dwordx4 v[44:47], v5, s[24:27], s63 offen offset:3072
  buffer_load_dwordx4 v[48:51], v1, s[24:27], s50 offen offset:0
  buffer_load_dwordx4 v[52:55], v1, s[24:27], s50 offen offset:1024
  buffer_load_dwordx4 v[56:59], v1, s[24:27], s50 offen offset:2048
  buffer_load_dwordx4 v[60:63], v1, s[24:27], s50 offen offset:3072
  s_barrier
  s_setprio 2
  buffer_load_dwordx4 v[64:67], v1, s[24:27], s51 offen offset:0
  buffer_load_dwordx4 v[68:71], v1, s[24:27], s51 offen offset:1024
  buffer_load_dwordx4 v[72:75], v1, s[24:27], s51 offen offset:2048
  buffer_load_dwordx4 v[76:79], v1, s[24:27], s51 offen offset:3072
  buffer_load_dwordx4 v[96:99], v1, s[24:27], s53 offen offset:0
  buffer_load_dwordx4 v[100:103], v1, s[24:27], s53 offen offset:1024
  buffer_load_dwordx4 v[104:107], v1, s[24:27], s53 offen offset:2048
  buffer_load_dwordx4 v[108:111], v1, s[24:27], s53 offen offset:3072
  buffer_load_dwordx4 v[120:123], v8, s[24:27], s56 offen offset:0
  buffer_load_dwordx4 v[124:127], v8, s[24:27], s56 offen offset:16
  buffer_load_dwordx4 v[80:83], v1, s[24:27], s52 offen offset:0
  buffer_load_dwordx4 v[84:87], v1, s[24:27], s52 offen offset:1024
  buffer_load_dwordx4 v[88:91], v1, s[24:27], s52 offen offset:2048
  buffer_load_dwordx4 v[92:95], v1, s[24:27], s52 offen offset:3072
  v_mul_u32_u24 v9, 144, v2
  v_lshl_add_u32 v9, v3, 3, v9
  s_lshl_b32 s55, s60, 5
  s_add_u32 s55, s55, 131072
  v_add_u32 v9, s55, v9
  v_lshrrev_b32 v10, 2, v2
  v_lshlrev_b32 v10, 3, v10
  v_and_b32 v11, 3, v2
  v_add_u32 v10, v10, v11
  v_mul_u32_u24 v10, 144, v10
  v_lshl_add_u32 v10, v3, 4, v10
  v_add_u32 v10, 131072, v10
  v_lshlrev_b32 v11, 6, v7
  v_lshl_add_u32 v11, v3, 4, v11
  s_add_u32 s69, s68, 2113536
  s_add_u32 m0, s68, 16384
  s_nop 0
  buffer_load_dwordx4 v1, s[24:27], s69 offen lds
  s_add_u32 s69, s68, 2179072
  s_add_u32 m0, s68, 81920
  s_nop 0
  buffer_load_dwordx4 v1, s[24:27], s69 offen lds
  s_add_u32 s69, s68, 2117632
  s_add_u32 m0, s68, 20480
  s_nop 0
  buffer_load_dwordx4 v1, s[24:27], s69 offen lds
  s_add_u32 s69, s68, 2183168
  s_add_u32 m0, s68, 86016
  s_nop 0
  buffer_load_dwordx4 v1, s[24:27], s69 offen lds
  s_waitcnt vmcnt(18)
  v_xor_b32 v128, 0x80008000, v56
  v_xor_b32 v129, 0x80008000, v57
  v_xor_b32 v130, 0x80008000, v58
  v_xor_b32 v131, 0x80008000, v59
  v_xor_b32 v132, 0x80008000, v60
  v_xor_b32 v133, 0x80008000, v61
  v_xor_b32 v134, 0x80008000, v62
  v_xor_b32 v135, 0x80008000, v63
  s_add_u32 s69, s68, 2121728
  s_add_u32 m0, s68, 24576
  s_nop 0
  buffer_load_dwordx4 v1, s[24:27], s69 offen lds
  s_nop 0
  v_mfma_f32_16x16x32_bf16 v[144:147], v[16:19], v[48:51], 0
  v_mfma_f32_16x16x32_bf16 v[148:151], v[24:27], v[48:51], 0
  v_mfma_f32_16x16x32_bf16 v[152:155], v[32:35], v[48:51], 0
  v_mfma_f32_16x16x32_bf16 v[156:159], v[40:43], v[48:51], 0
  v_mfma_f32_16x16x32_bf16 v[144:147], v[32:35], v[56:59], v[144:147]
  v_mfma_f32_16x16x32_bf16 v[148:151], v[40:43], v[56:59], v[148:151]
  v_mfma_f32_16x16x32_bf16 v[152:155], v[16:19], v[128:131], v[152:155]
  s_add_u32 s69, s68, 2187264
  s_add_u32 m0, s68, 90112
  s_nop 0
  buffer_load_dwordx4 v1, s[24:27], s69 offen lds
  v_mfma_f32_16x16x32_bf16 v[156:159], v[24:27], v[128:131], v[156:159]
  v_mfma_f32_16x16x32_bf16 v[144:147], v[20:23], v[52:55], v[144:147]
  v_mfma_f32_16x16x32_bf16 v[148:151], v[28:31], v[52:55], v[148:151]
  v_mfma_f32_16x16x32_bf16 v[152:155], v[36:39], v[52:55], v[152:155]
  v_mfma_f32_16x16x32_bf16 v[156:159], v[44:47], v[52:55], v[156:159]
  v_mfma_f32_16x16x32_bf16 v[144:147], v[36:39], v[60:63], v[144:147]
  v_mfma_f32_16x16x32_bf16 v[148:151], v[44:47], v[60:63], v[148:151]
  v_mfma_f32_16x16x32_bf16 v[152:155], v[20:23], v[132:135], v[152:155]
  s_add_u32 s69, s68, 2125824
  s_add_u32 m0, s68, 28672
  s_nop 0
  buffer_load_dwordx4 v1, s[24:27], s69 offen lds
  v_mfma_f32_16x16x32_bf16 v[156:159], v[28:31], v[132:135], v[156:159]
  s_waitcnt vmcnt(13)
  v_xor_b32 v136, 0x80008000, v104
  v_xor_b32 v137, 0x80008000, v105
  v_xor_b32 v138, 0x80008000, v106
  v_xor_b32 v139, 0x80008000, v107
  v_xor_b32 v140, 0x80008000, v108
  v_xor_b32 v141, 0x80008000, v109
  v_xor_b32 v142, 0x80008000, v110
  s_add_u32 s69, s68, 2191360
  s_add_u32 m0, s68, 94208
  s_nop 0
  buffer_load_dwordx4 v1, s[24:27], s69 offen lds
  v_xor_b32 v143, 0x80008000, v111
  v_mul_f32 v16, v144, v64
  v_mul_f32 v24, v152, v64
  v_mul_f32 v17, v145, v65
  v_mul_f32 v25, v153, v65
  v_mul_f32 v18, v146, v66
  v_mul_f32 v26, v154, v66
  v_mul_f32 v19, v147, v67
  s_add_u32 s69, s68, 2129920
  s_add_u32 m0, s68, 32768
  s_nop 0
  buffer_load_dwordx4 v1, s[24:27], s69 offen lds
  v_mul_f32 v27, v155, v67
  v_mul_f32 v20, v148, v72
  v_mul_f32 v28, v156, v72
  v_mul_f32 v21, v149, v73
  v_mul_f32 v29, v157, v73
  v_mul_f32 v22, v150, v74
  v_mul_f32 v30, v158, v74
  v_mul_f32 v23, v151, v75
  s_add_u32 s69, s68, 2195456
  s_add_u32 m0, s68, 98304
  s_nop 0
  buffer_load_dwordx4 v1, s[24:27], s69 offen lds
  v_mul_f32 v31, v159, v75
  v_fmac_f32 v16, v152, v68
  v_fma_f32 v24, -v144, v68, v24
  v_fmac_f32 v17, v153, v69
  v_fma_f32 v25, -v145, v69, v25
  v_fmac_f32 v18, v154, v70
  v_fma_f32 v26, -v146, v70, v26
  v_fmac_f32 v19, v155, v71
  s_add_u32 s69, s68, 2134016
  s_add_u32 m0, s68, 36864
  s_nop 0
  buffer_load_dwordx4 v1, s[24:27], s69 offen lds
  v_fma_f32 v27, -v147, v71, v27
  v_fmac_f32 v20, v156, v76
  v_fma_f32 v28, -v148, v76, v28
  v_fmac_f32 v21, v157, v77
  v_fma_f32 v29, -v149, v77, v29
  v_fmac_f32 v22, v158, v78
  v_fma_f32 v30, -v150, v78, v30
  v_fmac_f32 v23, v159, v79
  s_add_u32 s69, s68, 2199552
  s_add_u32 m0, s68, 102400
  s_nop 0
  buffer_load_dwordx4 v1, s[24:27], s69 offen lds
  v_fma_f32 v31, -v151, v79, v31
  v_cvt_pk_bf16_f32 v32, v16, v17
  v_cvt_pk_bf16_f32 v33, v18, v19
  v_cvt_pk_bf16_f32 v34, v20, v21
  v_cvt_pk_bf16_f32 v35, v22, v23
  v_cvt_pk_bf16_f32 v36, v24, v25
  v_cvt_pk_bf16_f32 v37, v26, v27
  v_cvt_pk_bf16_f32 v38, v28, v29
  s_add_u32 s69, s68, 2138112
  s_add_u32 m0, s68, 40960
  s_nop 0
  buffer_load_dwordx4 v1, s[24:27], s69 offen lds
  v_cvt_pk_bf16_f32 v39, v30, v31
  s_nop 1
  v_mfma_f32_16x16x32_bf16 v[144:147], v[96:99], v[32:35], 0
  v_mfma_f32_16x16x32_bf16 v[148:151], v[100:103], v[32:35], 0
  v_mfma_f32_16x16x32_bf16 v[152:155], v[96:99], v[36:39], 0
  v_mfma_f32_16x16x32_bf16 v[156:159], v[100:103], v[36:39], 0
  v_mfma_f32_16x16x32_bf16 v[144:147], v[104:107], v[36:39], v[144:147]
  v_mfma_f32_16x16x32_bf16 v[148:151], v[108:111], v[36:39], v[148:151]
  s_add_u32 s69, s68, 2203648
  s_add_u32 m0, s68, 106496
  s_nop 0
  buffer_load_dwordx4 v1, s[24:27], s69 offen lds
  v_mfma_f32_16x16x32_bf16 v[152:155], v[136:139], v[32:35], v[152:155]
  v_mfma_f32_16x16x32_bf16 v[156:159], v[140:143], v[32:35], v[156:159]
  s_waitcnt vmcnt(18)
  v_lshlrev_b32 v112, 16, v120
  v_and_b32 v120, 0xffff0000, v120
  v_lshlrev_b32 v113, 16, v121
  v_and_b32 v121, 0xffff0000, v121
  v_lshlrev_b32 v114, 16, v122
  v_and_b32 v122, 0xffff0000, v122
  s_add_u32 s69, s68, 2142208
  s_add_u32 m0, s68, 45056
  s_nop 0
  buffer_load_dwordx4 v1, s[24:27], s69 offen lds
  v_lshlrev_b32 v115, 16, v123
  v_and_b32 v123, 0xffff0000, v123
  v_lshlrev_b32 v116, 16, v124
  v_and_b32 v124, 0xffff0000, v124
  v_lshlrev_b32 v117, 16, v125
  v_and_b32 v125, 0xffff0000, v125
  v_lshlrev_b32 v118, 16, v126
  v_and_b32 v126, 0xffff0000, v126
  s_add_u32 s69, s68, 2207744
  s_add_u32 m0, s68, 110592
  s_nop 0
  buffer_load_dwordx4 v1, s[24:27], s69 offen lds
  v_lshlrev_b32 v119, 16, v127
  v_and_b32 v127, 0xffff0000, v127
  v_mul_f32 v16, v144, v112
  v_mul_f32 v24, v152, v112
  v_mul_f32 v17, v145, v113
  v_mul_f32 v25, v153, v113
  v_mul_f32 v18, v146, v114
  v_mul_f32 v26, v154, v114
  s_add_u32 s69, s68, 2146304
  s_add_u32 m0, s68, 49152
  s_nop 0
  buffer_load_dwordx4 v1, s[24:27], s69 offen lds
  v_mul_f32 v19, v147, v115
  v_mul_f32 v27, v155, v115
  v_mul_f32 v20, v148, v116
  v_mul_f32 v28, v156, v116
  v_mul_f32 v21, v149, v117
  v_mul_f32 v29, v157, v117
  v_mul_f32 v22, v150, v118
  v_mul_f32 v30, v158, v118
  s_add_u32 s69, s68, 2211840
  s_add_u32 m0, s68, 114688
  s_nop 0
  buffer_load_dwordx4 v1, s[24:27], s69 offen lds
  v_mul_f32 v23, v151, v119
  v_mul_f32 v31, v159, v119
  v_fma_f32 v16, -v152, v120, v16
  v_fmac_f32 v24, v144, v120
  v_fma_f32 v17, -v153, v121, v17
  v_fmac_f32 v25, v145, v121
  v_fma_f32 v18, -v154, v122, v18
  v_fmac_f32 v26, v146, v122
  s_add_u32 s69, s68, 2150400
  s_add_u32 m0, s68, 53248
  s_nop 0
  buffer_load_dwordx4 v1, s[24:27], s69 offen lds
  v_fma_f32 v19, -v155, v123, v19
  v_fmac_f32 v27, v147, v123
  v_fma_f32 v20, -v156, v124, v20
  v_fmac_f32 v28, v148, v124
  v_fma_f32 v21, -v157, v125, v21
  v_fmac_f32 v29, v149, v125
  v_fma_f32 v22, -v158, v126, v22
  v_fmac_f32 v30, v150, v126
  s_add_u32 s69, s68, 2215936
  s_add_u32 m0, s68, 118784
  s_nop 0
  buffer_load_dwordx4 v1, s[24:27], s69 offen lds
  v_fma_f32 v23, -v159, v127, v23
  v_fmac_f32 v31, v151, v127
  v_cvt_pk_bf16_f32 v32, v16, v17
  v_cvt_pk_bf16_f32 v33, v18, v19
  v_cvt_pk_bf16_f32 v34, v20, v21
  v_cvt_pk_bf16_f32 v35, v22, v23
  v_cvt_pk_bf16_f32 v36, v24, v25
  v_cvt_pk_bf16_f32 v37, v26, v27
  s_add_u32 s69, s68, 2154496
  s_add_u32 m0, s68, 57344
  s_nop 0
  buffer_load_dwordx4 v1, s[24:27], s69 offen lds
  v_cvt_pk_bf16_f32 v38, v28, v29
  v_cvt_pk_bf16_f32 v39, v30, v31
  s_nop 1
  v_mfma_f32_16x16x32_bf16 v[144:147], v[32:35], v[96:99], 0
  v_mfma_f32_16x16x32_bf16 v[148:151], v[32:35], v[100:103], 0
  v_mfma_f32_16x16x32_bf16 v[152:155], v[36:39], v[96:99], 0
  v_mfma_f32_16x16x32_bf16 v[156:159], v[36:39], v[100:103], 0
  v_mfma_f32_16x16x32_bf16 v[144:147], v[36:39], v[136:139], v[144:147]
  s_add_u32 s69, s68, 2220032
  s_add_u32 m0, s68, 122880
  s_nop 0
  buffer_load_dwordx4 v1, s[24:27], s69 offen lds
  v_mfma_f32_16x16x32_bf16 v[148:151], v[36:39], v[140:143], v[148:151]
  v_mfma_f32_16x16x32_bf16 v[152:155], v[32:35], v[104:107], v[152:155]
  v_mfma_f32_16x16x32_bf16 v[156:159], v[32:35], v[108:111], v[156:159]
  s_waitcnt vmcnt(22)
  s_nop 7
  v_mul_f32 v16, v144, v80
  v_mul_f32 v24, v152, v80
  v_mul_f32 v17, v145, v81
  v_mul_f32 v25, v153, v81
  s_add_u32 s69, s68, 2158592
  s_add_u32 m0, s68, 61440
  s_nop 0
  buffer_load_dwordx4 v1, s[24:27], s69 offen lds
  v_mul_f32 v18, v146, v82
  v_mul_f32 v26, v154, v82
  v_mul_f32 v19, v147, v83
  v_mul_f32 v27, v155, v83
  v_mul_f32 v20, v148, v88
  v_mul_f32 v28, v156, v88
  v_mul_f32 v21, v149, v89
  v_mul_f32 v29, v157, v89
  s_add_u32 s69, s68, 2224128
  s_add_u32 m0, s68, 126976
  s_nop 0
  buffer_load_dwordx4 v1, s[24:27], s69 offen lds
  v_mul_f32 v22, v150, v90
  v_mul_f32 v30, v158, v90
  v_mul_f32 v23, v151, v91
  v_mul_f32 v31, v159, v91
  v_fma_f32 v16, -v152, v84, v16
  v_fmac_f32 v24, v144, v84
  v_fma_f32 v17, -v153, v85, v17
  v_fmac_f32 v25, v145, v85
  v_fma_f32 v18, -v154, v86, v18
  v_fmac_f32 v26, v146, v86
  v_fma_f32 v19, -v155, v87, v19
  v_fmac_f32 v27, v147, v87
  v_fma_f32 v20, -v156, v92, v20
  v_fmac_f32 v28, v148, v92
  v_fma_f32 v21, -v157, v93, v21
  v_fmac_f32 v29, v149, v93
  v_fma_f32 v22, -v158, v94, v22
  v_fmac_f32 v30, v150, v94
  v_fma_f32 v23, -v159, v95, v23
  v_fmac_f32 v31, v151, v95
  v_cvt_pk_bf16_f32 v32, v16, v17
  v_cvt_pk_bf16_f32 v33, v18, v19
  v_cvt_pk_bf16_f32 v34, v20, v21
  v_cvt_pk_bf16_f32 v35, v22, v23
  v_cvt_pk_bf16_f32 v36, v24, v25
  v_cvt_pk_bf16_f32 v37, v26, v27
  v_cvt_pk_bf16_f32 v38, v28, v29
  v_cvt_pk_bf16_f32 v39, v30, v31
  ds_write_b64 v9, v[32:33] offset:0
  ds_write_b64 v9, v[34:35] offset:2304
  ds_write_b64 v9, v[36:37] offset:4608
  ds_write_b64 v9, v[38:39] offset:6912
  s_waitcnt vmcnt(0) lgkmcnt(0)
  s_barrier
  ds_read_b128 v[16:19], v10 offset:0
  ds_read_b128 v[20:23], v10 offset:64
  ds_read_b128 v[32:35], v10 offset:4608
  ds_read_b128 v[36:39], v10 offset:4672
  ds_read_b128 v[24:27], v10 offset:576
  ds_read_b128 v[28:31], v10 offset:640
  ds_read_b128 v[40:43], v10 offset:5184
  ds_read_b128 v[44:47], v10 offset:5248
  s_waitcnt lgkmcnt(0)
  v_mfma_f32_16x16x32_bf16 v[144:147], v[16:19], v[48:51], 0
  v_mfma_f32_16x16x32_bf16 v[148:151], v[24:27], v[48:51], 0
  v_mfma_f32_16x16x32_bf16 v[152:155], v[32:35], v[48:51], 0
  v_mfma_f32_16x16x32_bf16 v[156:159], v[40:43], v[48:51], 0
  v_mfma_f32_16x16x32_bf16 v[144:147], v[32:35], v[128:131], v[144:147]
  v_mfma_f32_16x16x32_bf16 v[148:151], v[40:43], v[128:131], v[148:151]
  v_mfma_f32_16x16x32_bf16 v[152:155], v[16:19], v[56:59], v[152:155]
  v_mfma_f32_16x16x32_bf16 v[156:159], v[24:27], v[56:59], v[156:159]
  v_mfma_f32_16x16x32_bf16 v[144:147], v[20:23], v[52:55], v[144:147]
  v_mfma_f32_16x16x32_bf16 v[148:151], v[28:31], v[52:55], v[148:151]
  v_mfma_f32_16x16x32_bf16 v[152:155], v[36:39], v[52:55], v[152:155]
  v_mfma_f32_16x16x32_bf16 v[156:159], v[44:47], v[52:55], v[156:159]
  v_mfma_f32_16x16x32_bf16 v[144:147], v[36:39], v[132:135], v[144:147]
  v_mfma_f32_16x16x32_bf16 v[148:151], v[44:47], v[132:135], v[148:151]
  v_mfma_f32_16x16x32_bf16 v[152:155], v[20:23], v[60:63], v[152:155]
  v_mfma_f32_16x16x32_bf16 v[156:159], v[28:31], v[60:63], v[156:159]
  s_nop 7
  v_cvt_pk_bf16_f32 v112, v144, v145
  v_cvt_pk_bf16_f32 v113, v146, v147
  v_cvt_pk_bf16_f32 v114, v148, v149
  v_cvt_pk_bf16_f32 v115, v150, v151
  v_cvt_pk_bf16_f32 v116, v152, v153
  v_cvt_pk_bf16_f32 v117, v154, v155
  v_cvt_pk_bf16_f32 v118, v156, v157
  v_cvt_pk_bf16_f32 v119, v158, v159
  buffer_store_dwordx4 v[112:115], v11, s[24:27], s64 offen sc1
  buffer_store_dwordx4 v[116:119], v11, s[24:27], s65 offen sc1
  s_cmp_lg_u32 s2, 0
  s_cbranch_scc1 .Lk2_fd
  s_mov_b32 s61, 256
  s_mov_b32 s62, 3149824
  s_mov_b32 s64, 16781568
  s_lshl_b32 s55, s61, 13
  s_lshl_b32 s56, s60, 11
  s_add_u32 s55, s55, s56
  s_add_u32 s56, s55, 13107200
  buffer_load_dwordx4 v[16:19], v5, s[24:27], s62 offen offset:0
  buffer_load_dwordx4 v[20:23], v5, s[24:27], s62 offen offset:2048
  buffer_load_dwordx4 v[24:27], v5, s[24:27], s62 offen offset:1024
  buffer_load_dwordx4 v[28:31], v5, s[24:27], s62 offen offset:3072
  buffer_load_dwordx4 v[32:35], v5, s[24:27], s63 offen offset:0
  buffer_load_dwordx4 v[36:39], v5, s[24:27], s63 offen offset:2048
  buffer_load_dwordx4 v[40:43], v5, s[24:27], s63 offen offset:1024
  buffer_load_dwordx4 v[44:47], v5, s[24:27], s63 offen offset:3072
  buffer_load_dwordx4 v[120:123], v8, s[24:27], s56 offen offset:0
  buffer_load_dwordx4 v[124:127], v8, s[24:27], s56 offen offset:16
  v_add_u32 v9, 9216, v9
  v_add_u32 v10, 9216, v10
  s_waitcnt vmcnt(2)
  s_nop 0
  v_mfma_f32_16x16x32_bf16 v[144:147], v[16:19], v[48:51], 0
  v_mfma_f32_16x16x32_bf16 v[148:151], v[24:27], v[48:51], 0
  v_mfma_f32_16x16x32_bf16 v[152:155], v[32:35], v[48:51], 0
  v_mfma_f32_16x16x32_bf16 v[156:159], v[40:43], v[48:51], 0
  v_mfma_f32_16x16x32_bf16 v[144:147], v[32:35], v[56:59], v[144:147]
  v_mfma_f32_16x16x32_bf16 v[148:151], v[40:43], v[56:59], v[148:151]
  v_mfma_f32_16x16x32_bf16 v[152:155], v[16:19], v[128:131], v[152:155]
  v_mfma_f32_16x16x32_bf16 v[156:159], v[24:27], v[128:131], v[156:159]
  v_mfma_f32_16x16x32_bf16 v[144:147], v[20:23], v[52:55], v[144:147]
  v_mfma_f32_16x16x32_bf16 v[148:151], v[28:31], v[52:55], v[148:151]
  v_mfma_f32_16x16x32_bf16 v[152:155], v[36:39], v[52:55], v[152:155]
  v_mfma_f32_16x16x32_bf16 v[156:159], v[44:47], v[52:55], v[156:159]
  v_mfma_f32_16x16x32_bf16 v[144:147], v[36:39], v[60:63], v[144:147]
  v_mfma_f32_16x16x32_bf16 v[148:151], v[44:47], v[60:63], v[148:151]
  v_mfma_f32_16x16x32_bf16 v[152:155], v[20:23], v[132:135], v[152:155]
  v_mfma_f32_16x16x32_bf16 v[156:159], v[28:31], v[132:135], v[156:159]
  s_waitcnt vmcnt(2)
  s_nop 7
  v_mul_f32 v16, v144, v64
  v_mul_f32 v24, v152, v64
  v_mul_f32 v17, v145, v65
  v_mul_f32 v25, v153, v65
  v_mul_f32 v18, v146, v66
  v_mul_f32 v26, v154, v66
  v_mul_f32 v19, v147, v67
  v_mul_f32 v27, v155, v67
  v_mul_f32 v20, v148, v72
  v_mul_f32 v28, v156, v72
  v_mul_f32 v21, v149, v73
  v_mul_f32 v29, v157, v73
  v_mul_f32 v22, v150, v74
  v_mul_f32 v30, v158, v74
  v_mul_f32 v23, v151, v75
  v_mul_f32 v31, v159, v75
  v_fmac_f32 v16, v152, v68
  v_fma_f32 v24, -v144, v68, v24
  v_fmac_f32 v17, v153, v69
  v_fma_f32 v25, -v145, v69, v25
  v_fmac_f32 v18, v154, v70
  v_fma_f32 v26, -v146, v70, v26
  v_fmac_f32 v19, v155, v71
  v_fma_f32 v27, -v147, v71, v27
  v_fmac_f32 v20, v156, v76
  v_fma_f32 v28, -v148, v76, v28
  v_fmac_f32 v21, v157, v77
  v_fma_f32 v29, -v149, v77, v29
  v_fmac_f32 v22, v158, v78
  v_fma_f32 v30, -v150, v78, v30
  v_fmac_f32 v23, v159, v79
  v_fma_f32 v31, -v151, v79, v31
  v_cvt_pk_bf16_f32 v32, v16, v17
  v_cvt_pk_bf16_f32 v33, v18, v19
  v_cvt_pk_bf16_f32 v34, v20, v21
  v_cvt_pk_bf16_f32 v35, v22, v23
  v_cvt_pk_bf16_f32 v36, v24, v25
  v_cvt_pk_bf16_f32 v37, v26, v27
  v_cvt_pk_bf16_f32 v38, v28, v29
  v_cvt_pk_bf16_f32 v39, v30, v31
  s_nop 1
  v_mfma_f32_16x16x32_bf16 v[144:147], v[96:99], v[32:35], 0
  v_mfma_f32_16x16x32_bf16 v[148:151], v[100:103], v[32:35], 0
  v_mfma_f32_16x16x32_bf16 v[152:155], v[96:99], v[36:39], 0
  v_mfma_f32_16x16x32_bf16 v[156:159], v[100:103], v[36:39], 0
  v_mfma_f32_16x16x32_bf16 v[144:147], v[104:107], v[36:39], v[144:147]
  v_mfma_f32_16x16x32_bf16 v[148:151], v[108:111], v[36:39], v[148:151]
  v_mfma_f32_16x16x32_bf16 v[152:155], v[136:139], v[32:35], v[152:155]
  v_mfma_f32_16x16x32_bf16 v[156:159], v[140:143], v[32:35], v[156:159]
  s_waitcnt vmcnt(0)
  v_lshlrev_b32 v112, 16, v120
  v_and_b32 v120, 0xffff0000, v120
  v_lshlrev_b32 v113, 16, v121
  v_and_b32 v121, 0xffff0000, v121
  v_lshlrev_b32 v114, 16, v122
  v_and_b32 v122, 0xffff0000, v122
  v_lshlrev_b32 v115, 16, v123
  v_and_b32 v123, 0xffff0000, v123
  v_lshlrev_b32 v116, 16, v124
  v_and_b32 v124, 0xffff0000, v124
  v_lshlrev_b32 v117, 16, v125
  v_and_b32 v125, 0xffff0000, v125
  v_lshlrev_b32 v118, 16, v126
  v_and_b32 v126, 0xffff0000, v126
  v_lshlrev_b32 v119, 16, v127
  v_and_b32 v127, 0xffff0000, v127
  v_mul_f32 v16, v144, v112
  v_mul_f32 v24, v152, v112
  v_mul_f32 v17, v145, v113
  v_mul_f32 v25, v153, v113
  v_mul_f32 v18, v146, v114
  v_mul_f32 v26, v154, v114
  v_mul_f32 v19, v147, v115
  v_mul_f32 v27, v155, v115
  v_mul_f32 v20, v148, v116
  v_mul_f32 v28, v156, v116
  v_mul_f32 v21, v149, v117
  v_mul_f32 v29, v157, v117
  v_mul_f32 v22, v150, v118
  v_mul_f32 v30, v158, v118
  v_mul_f32 v23, v151, v119
  v_mul_f32 v31, v159, v119
  v_fma_f32 v16, -v152, v120, v16
  v_fmac_f32 v24, v144, v120
  v_fma_f32 v17, -v153, v121, v17
  v_fmac_f32 v25, v145, v121
  v_fma_f32 v18, -v154, v122, v18
  v_fmac_f32 v26, v146, v122
  v_fma_f32 v19, -v155, v123, v19
  v_fmac_f32 v27, v147, v123
  v_fma_f32 v20, -v156, v124, v20
  v_fmac_f32 v28, v148, v124
  v_fma_f32 v21, -v157, v125, v21
  v_fmac_f32 v29, v149, v125
  v_fma_f32 v22, -v158, v126, v22
  v_fmac_f32 v30, v150, v126
  v_fma_f32 v23, -v159, v127, v23
  v_fmac_f32 v31, v151, v127
  v_cvt_pk_bf16_f32 v32, v16, v17
  v_cvt_pk_bf16_f32 v33, v18, v19
  v_cvt_pk_bf16_f32 v34, v20, v21
  v_cvt_pk_bf16_f32 v35, v22, v23
  v_cvt_pk_bf16_f32 v36, v24, v25
  v_cvt_pk_bf16_f32 v37, v26, v27
  v_cvt_pk_bf16_f32 v38, v28, v29
  v_cvt_pk_bf16_f32 v39, v30, v31
  s_nop 1
  v_mfma_f32_16x16x32_bf16 v[144:147], v[32:35], v[96:99], 0
  v_mfma_f32_16x16x32_bf16 v[148:151], v[32:35], v[100:103], 0
  v_mfma_f32_16x16x32_bf16 v[152:155], v[36:39], v[96:99], 0
  v_mfma_f32_16x16x32_bf16 v[156:159], v[36:39], v[100:103], 0
  v_mfma_f32_16x16x32_bf16 v[144:147], v[36:39], v[136:139], v[144:147]
  v_mfma_f32_16x16x32_bf16 v[148:151], v[36:39], v[140:143], v[148:151]
  v_mfma_f32_16x16x32_bf16 v[152:155], v[32:35], v[104:107], v[152:155]
  v_mfma_f32_16x16x32_bf16 v[156:159], v[32:35], v[108:111], v[156:159]
  s_waitcnt vmcnt(2)
  s_nop 7
  v_mul_f32 v16, v144, v80
  v_mul_f32 v24, v152, v80
  v_mul_f32 v17, v145, v81
  v_mul_f32 v25, v153, v81
  v_mul_f32 v18, v146, v82
  v_mul_f32 v26, v154, v82
  v_mul_f32 v19, v147, v83
  v_mul_f32 v27, v155, v83
  v_mul_f32 v20, v148, v88
  v_mul_f32 v28, v156, v88
  v_mul_f32 v21, v149, v89
  v_mul_f32 v29, v157, v89
  v_mul_f32 v22, v150, v90
  v_mul_f32 v30, v158, v90
  v_mul_f32 v23, v151, v91
  v_mul_f32 v31, v159, v91
  v_fma_f32 v16, -v152, v84, v16
  v_fmac_f32 v24, v144, v84
  v_fma_f32 v17, -v153, v85, v17
  v_fmac_f32 v25, v145, v85
  v_fma_f32 v18, -v154, v86, v18
  v_fmac_f32 v26, v146, v86
  v_fma_f32 v19, -v155, v87, v19
  v_fmac_f32 v27, v147, v87
  v_fma_f32 v20, -v156, v92, v20
  v_fmac_f32 v28, v148, v92
  v_fma_f32 v21, -v157, v93, v21
  v_fmac_f32 v29, v149, v93
  v_fma_f32 v22, -v158, v94, v22
  v_fmac_f32 v30, v150, v94
  v_fma_f32 v23, -v159, v95, v23
  v_fmac_f32 v31, v151, v95
  v_cvt_pk_bf16_f32 v32, v16, v17
  v_cvt_pk_bf16_f32 v33, v18, v19
  v_cvt_pk_bf16_f32 v34, v20, v21
  v_cvt_pk_bf16_f32 v35, v22, v23
  v_cvt_pk_bf16_f32 v36, v24, v25
  v_cvt_pk_bf16_f32 v37, v26, v27
  v_cvt_pk_bf16_f32 v38, v28, v29
  v_cvt_pk_bf16_f32 v39, v30, v31
  ds_write_b64 v9, v[32:33] offset:0
  ds_write_b64 v9, v[34:35] offset:2304
  ds_write_b64 v9, v[36:37] offset:4608
  ds_write_b64 v9, v[38:39] offset:6912
  s_waitcnt lgkmcnt(0)
  s_barrier
  ds_read_b128 v[16:19], v10 offset:0
  ds_read_b128 v[20:23], v10 offset:64
  ds_read_b128 v[32:35], v10 offset:4608
  ds_read_b128 v[36:39], v10 offset:4672
  ds_read_b128 v[24:27], v10 offset:576
  ds_read_b128 v[28:31], v10 offset:640
  ds_read_b128 v[40:43], v10 offset:5184
  ds_read_b128 v[44:47], v10 offset:5248
  s_waitcnt lgkmcnt(0)
  v_mfma_f32_16x16x32_bf16 v[144:147], v[16:19], v[48:51], 0
  v_mfma_f32_16x16x32_bf16 v[148:151], v[24:27], v[48:51], 0
  v_mfma_f32_16x16x32_bf16 v[152:155], v[32:35], v[48:51], 0
  v_mfma_f32_16x16x32_bf16 v[156:159], v[40:43], v[48:51], 0
  v_mfma_f32_16x16x32_bf16 v[144:147], v[32:35], v[128:131], v[144:147]
  v_mfma_f32_16x16x32_bf16 v[148:151], v[40:43], v[128:131], v[148:151]
  v_mfma_f32_16x16x32_bf16 v[152:155], v[16:19], v[56:59], v[152:155]
  v_mfma_f32_16x16x32_bf16 v[156:159], v[24:27], v[56:59], v[156:159]
  v_mfma_f32_16x16x32_bf16 v[144:147], v[20:23], v[52:55], v[144:147]
  v_mfma_f32_16x16x32_bf16 v[148:151], v[28:31], v[52:55], v[148:151]
  v_mfma_f32_16x16x32_bf16 v[152:155], v[36:39], v[52:55], v[152:155]
  v_mfma_f32_16x16x32_bf16 v[156:159], v[44:47], v[52:55], v[156:159]
  v_mfma_f32_16x16x32_bf16 v[144:147], v[36:39], v[132:135], v[144:147]
  v_mfma_f32_16x16x32_bf16 v[148:151], v[44:47], v[132:135], v[148:151]
  v_mfma_f32_16x16x32_bf16 v[152:155], v[20:23], v[60:63], v[152:155]
  v_mfma_f32_16x16x32_bf16 v[156:159], v[28:31], v[60:63], v[156:159]
  s_nop 7
  v_cvt_pk_bf16_f32 v112, v144, v145
  v_cvt_pk_bf16_f32 v113, v146, v147
  v_cvt_pk_bf16_f32 v114, v148, v149
  v_cvt_pk_bf16_f32 v115, v150, v151
  v_cvt_pk_bf16_f32 v116, v152, v153
  v_cvt_pk_bf16_f32 v117, v154, v155
  v_cvt_pk_bf16_f32 v118, v156, v157
  v_cvt_pk_bf16_f32 v119, v158, v159
  buffer_store_dwordx4 v[112:115], v11, s[24:27], s64 offen sc1
  buffer_store_dwordx4 v[116:119], v11, s[24:27], s65 offen sc1
.Lk2_fd:
  s_setprio 0
.Lk2_att:
  v_mov_b32 v120, v12
  v_mov_b32 v121, v13
  v_mov_b32 v122, v14
  v_mov_b32 v123, v15
  v_and_b32 v3, 27, v0
  v_mov_b32 v4, 0x3f803f80
  v_cmp_eq_u32 vcc, 16, v3
  v_cndmask_b32 v4, 0, v4, vcc
  v_mov_b32 v64, 0
  v_mov_b32 v104, v4
  v_mov_b32 v65, 0
  v_mov_b32 v105, v4
  v_mov_b32 v66, 0
  v_mov_b32 v106, v4
  v_mov_b32 v67, 0
  v_mov_b32 v107, v4
  v_mov_b32 v68, 0
  v_mov_b32 v108, v4
  v_mov_b32 v69, 0
  v_mov_b32 v109, v4
  v_mov_b32 v70, 0
  v_mov_b32 v110, v4
  v_mov_b32 v71, 0
  v_mov_b32 v111, v4
  v_mov_b32 v72, 0
  v_mov_b32 v112, v4
  v_mov_b32 v73, 0
  v_mov_b32 v113, v4
  v_mov_b32 v74, 0
  v_mov_b32 v114, v4
  v_mov_b32 v75, 0
  v_mov_b32 v115, v4
  v_mov_b32 v76, 0
  v_mov_b32 v116, v4
  v_mov_b32 v77, 0
  v_mov_b32 v117, v4
  v_mov_b32 v78, 0
  v_mov_b32 v118, v4
  v_mov_b32 v79, 0
  v_mov_b32 v119, v4
  v_lshrrev_b32 v3, 5, v0
  v_and_b32 v4, 15, v0
  v_lshlrev_b32 v3, 8, v3
  v_lshl_add_u32 v2, v4, 4, v3
  v_add_u32 v2, 0x10000, v2
.Lk2_main:
  v_mov_b32 v10, v1
  v_mov_b32 v11, v2
  s_mov_b32 s53, 0
  ds_read_b128 v[96:99], v1
  ds_read_b128 v[100:103], v1 offset:1024
  v_mov_b32 v48, 0
  v_mov_b32 v49, 0
  v_mov_b32 v50, 0
  v_mov_b32 v51, 0
  v_mov_b32 v52, 0
  v_mov_b32 v53, 0
  v_mov_b32 v54, 0
  v_mov_b32 v55, 0
  v_mov_b32 v56, 0
  v_mov_b32 v57, 0
  v_mov_b32 v58, 0
  v_mov_b32 v59, 0
  v_mov_b32 v60, 0
  v_mov_b32 v61, 0
  v_mov_b32 v62, 0
  v_mov_b32 v63, 0
  v_mov_b32 v88, 0
  v_mov_b32 v89, 0
  v_mov_b32 v90, 0
  v_mov_b32 v91, 0
  v_mov_b32 v92, 0
  v_mov_b32 v93, 0
  v_mov_b32 v94, 0
  v_mov_b32 v95, 0
  s_waitcnt lgkmcnt(1)
  v_mfma_f32_32x32x16_bf16 v[16:31], v[96:99], v[120:123], v[64:79]
  s_waitcnt lgkmcnt(0)
  s_nop 10
.Lk2_loop:
  s_cmp_lg_u32 s53, s49
  s_cbranch_scc1 .Lk2_nb
  s_barrier
  s_mov_b32 s49, s70
  s_mov_b32 s70, -1
.Lk2_nb:
  s_cmp_lg_u32 s53, s67
  s_cbranch_scc1 .Lk2_np
  s_mov_b32 s67, -1
  s_cmp_ge_u32 s3, 4
  s_cbranch_scc1 .Lk2_pf
  s_and_b32 s50, s2, 15
  s_lshl_b32 s50, s50, 9
  s_add_u32 s50, s50, 11534592
  v_mov_b32 v128, 1
  v_mov_b32 v129, 0
  s_waitcnt vmcnt(0)
  s_mov_b64 exec, 1
  buffer_atomic_add v128, v129, s[24:27], s50 offen sc1
  s_mov_b64 exec, -1
  s_branch .Lk2_np
.Lk2_pf:
  s_setprio 0
  s_mov_b32 s32, s12
  s_mov_b32 s33, s13
  s_mov_b32 s34, 524288
  s_mov_b32 s35, 0x00020000
  s_lshl_b32 s50, s41, 14
  s_lshl_b32 s51, s68, 2
  s_add_u32 s50, s50, s51
  s_add_u32 s51, s50, 9437184
  buffer_load_dwordx4 v[128:131], v1, s[32:35], s50 offen offset:0
  buffer_load_dwordx4 v[132:135], v1, s[32:35], s50 offen offset:1024
  buffer_load_dwordx4 v[136:139], v1, s[32:35], s50 offen offset:2048
  buffer_load_dwordx4 v[140:143], v1, s[32:35], s50 offen offset:3072
  buffer_load_dwordx4 v[144:147], v1, s[24:27], s51 offen offset:0
  buffer_load_dwordx4 v[148:151], v1, s[24:27], s51 offen offset:1024
  buffer_load_dwordx4 v[152:155], v1, s[24:27], s51 offen offset:2048
  buffer_load_dwordx4 v[156:159], v1, s[24:27], s51 offen offset:3072
.Lk2_np:
  v_mfma_f32_32x32x16_bf16 v[32:47], v[100:103], v[120:123], v[64:79]
  ds_read_b128 v[96:99], v10 offset:2048
  s_mov_b64 exec, s[46:47]
  ds_read_b128 v[104:107], v11 offset:0
  ds_read_b128 v[108:111], v11 offset:512
  s_mov_b64 exec, -1
  v_exp_f32 v16, v16
  v_exp_f32 v17, v17
  v_exp_f32 v18, v18
  v_exp_f32 v19, v19
  v_cvt_pk_bf16_f32 v80, v16, v17
  v_exp_f32 v20, v20
  v_exp_f32 v21, v21
  v_cvt_pk_bf16_f32 v81, v18, v19
  v_mfma_f32_32x32x16_bf16 v[48:63], v[112:115], v[88:91], v[48:63]
  v_exp_f32 v22, v22
  v_exp_f32 v23, v23
  v_cvt_pk_bf16_f32 v82, v20, v21
  v_exp_f32 v24, v24
  v_exp_f32 v25, v25
  v_cvt_pk_bf16_f32 v83, v22, v23
  v_exp_f32 v26, v26
  v_exp_f32 v27, v27
  v_mfma_f32_32x32x16_bf16 v[48:63], v[116:119], v[92:95], v[48:63]
  v_cvt_pk_bf16_f32 v84, v24, v25
  v_exp_f32 v28, v28
  v_exp_f32 v29, v29
  v_cvt_pk_bf16_f32 v85, v26, v27
  v_exp_f32 v30, v30
  v_exp_f32 v31, v31
  v_cvt_pk_bf16_f32 v86, v28, v29
  s_waitcnt lgkmcnt(0)
  v_cvt_pk_bf16_f32 v87, v30, v31
  v_mfma_f32_32x32x16_bf16 v[16:31], v[96:99], v[120:123], v[64:79]
  ds_read_b128 v[100:103], v10 offset:3072
  s_mov_b64 exec, s[46:47]
  ds_read_b128 v[112:115], v11 offset:1024
  ds_read_b128 v[116:119], v11 offset:1536
  s_mov_b64 exec, -1
  v_exp_f32 v32, v32
  v_exp_f32 v33, v33
  v_exp_f32 v34, v34
  v_exp_f32 v35, v35
  v_cvt_pk_bf16_f32 v88, v32, v33
  v_exp_f32 v36, v36
  v_exp_f32 v37, v37
  v_cvt_pk_bf16_f32 v89, v34, v35
  v_mfma_f32_32x32x16_bf16 v[48:63], v[104:107], v[80:83], v[48:63]
  v_exp_f32 v38, v38
  v_exp_f32 v39, v39
  v_cvt_pk_bf16_f32 v90, v36, v37
  v_exp_f32 v40, v40
  v_exp_f32 v41, v41
  v_cvt_pk_bf16_f32 v91, v38, v39
  v_exp_f32 v42, v42
  v_exp_f32 v43, v43
  v_mfma_f32_32x32x16_bf16 v[48:63], v[108:111], v[84:87], v[48:63]
  v_cvt_pk_bf16_f32 v92, v40, v41
  v_exp_f32 v44, v44
  v_exp_f32 v45, v45
  v_cvt_pk_bf16_f32 v93, v42, v43
  v_exp_f32 v46, v46
  v_exp_f32 v47, v47
  v_cvt_pk_bf16_f32 v94, v44, v45
  s_waitcnt lgkmcnt(0)
  v_cvt_pk_bf16_f32 v95, v46, v47
  v_mfma_f32_32x32x16_bf16 v[32:47], v[100:103], v[120:123], v[64:79]
  ds_read_b128 v[96:99], v10 offset:4096
  s_mov_b64 exec, s[46:47]
  ds_read_b128 v[104:107], v11 offset:2048
  ds_read_b128 v[108:111], v11 offset:2560
  s_mov_b64 exec, -1
  v_exp_f32 v16, v16
  v_exp_f32 v17, v17
  v_exp_f32 v18, v18
  v_exp_f32 v19, v19
  v_cvt_pk_bf16_f32 v80, v16, v17
  v_exp_f32 v20, v20
  v_exp_f32 v21, v21
  v_cvt_pk_bf16_f32 v81, v18, v19
  v_mfma_f32_32x32x16_bf16 v[48:63], v[112:115], v[88:91], v[48:63]
  v_exp_f32 v22, v22
  v_exp_f32 v23, v23
  v_cvt_pk_bf16_f32 v82, v20, v21
  v_exp_f32 v24, v24
  v_exp_f32 v25, v25
  v_cvt_pk_bf16_f32 v83, v22, v23
  v_exp_f32 v26, v26
  v_exp_f32 v27, v27
  v_mfma_f32_32x32x16_bf16 v[48:63], v[116:119], v[92:95], v[48:63]
  v_cvt_pk_bf16_f32 v84, v24, v25
  v_exp_f32 v28, v28
  v_exp_f32 v29, v29
  v_cvt_pk_bf16_f32 v85, v26, v27
  v_exp_f32 v30, v30
  v_exp_f32 v31, v31
  v_cvt_pk_bf16_f32 v86, v28, v29
  s_waitcnt lgkmcnt(0)
  v_cvt_pk_bf16_f32 v87, v30, v31
  v_mfma_f32_32x32x16_bf16 v[16:31], v[96:99], v[120:123], v[64:79]
  ds_read_b128 v[100:103], v10 offset:5120
  s_mov_b64 exec, s[46:47]
  ds_read_b128 v[112:115], v11 offset:3072
  ds_read_b128 v[116:119], v11 offset:3584
  s_mov_b64 exec, -1
  v_exp_f32 v32, v32
  v_exp_f32 v33, v33
  v_exp_f32 v34, v34
  v_exp_f32 v35, v35
  v_cvt_pk_bf16_f32 v88, v32, v33
  v_exp_f32 v36, v36
  v_exp_f32 v37, v37
  v_cvt_pk_bf16_f32 v89, v34, v35
  v_mfma_f32_32x32x16_bf16 v[48:63], v[104:107], v[80:83], v[48:63]
  v_exp_f32 v38, v38
  v_exp_f32 v39, v39
  v_cvt_pk_bf16_f32 v90, v36, v37
  v_exp_f32 v40, v40
  v_exp_f32 v41, v41
  v_cvt_pk_bf16_f32 v91, v38, v39
  v_exp_f32 v42, v42
  v_exp_f32 v43, v43
  v_mfma_f32_32x32x16_bf16 v[48:63], v[108:111], v[84:87], v[48:63]
  v_cvt_pk_bf16_f32 v92, v40, v41
  v_exp_f32 v44, v44
  v_exp_f32 v45, v45
  v_cvt_pk_bf16_f32 v93, v42, v43
  v_exp_f32 v46, v46
  v_exp_f32 v47, v47
  v_cvt_pk_bf16_f32 v94, v44, v45
  v_add_u32 v10, 4096, v10
  v_add_u32 v11, 4096, v11
  s_add_u32 s53, s53, 1
  s_cmp_lg_u32 s53, 16
  s_waitcnt lgkmcnt(0)
  v_cvt_pk_bf16_f32 v95, v46, v47
  s_cbranch_scc1 .Lk2_loop
  s_nop 1
  v_mfma_f32_32x32x16_bf16 v[48:63], v[112:115], v[88:91], v[48:63]
  v_mfma_f32_32x32x16_bf16 v[48:63], v[116:119], v[92:95], v[48:63]
  s_nop 11
  s_cmp_lg_u32 s48, 0
  s_cbranch_scc1 .Lk2_fin
  v_add_f32 v3, abs(v48), abs(v49)
  v_add_f32 v3, v3, abs(v50)
  v_add_f32 v3, v3, abs(v51)
  v_add_f32 v3, v3, abs(v52)
  v_add_f32 v3, v3, abs(v53)
  v_add_f32 v3, v3, abs(v54)
  v_add_f32 v3, v3, abs(v55)
  s_mov_b32 s50, 0x17800000
  s_mov_b32 s51, 0x67800000
  s_mov_b32 s52, 0x7b800000
  v_cmp_nle_f32 s[54:55], s50, v56
  v_cmp_nge_f32 s[56:57], s51, v56
  v_cmp_nge_f32 s[58:59], s52, v3
  s_nop 3
  s_or_b64 s[54:55], s[54:55], s[56:57]
  s_or_b64 s[54:55], s[54:55], s[58:59]
  s_cbranch_scc0 .Lk2_fin
  s_mov_b32 s48, 1
  s_mov_b32 s50, 64
  v_mov_b32 v3, 0xff800000
  v_mov_b32 v4, v1
.Lk2_mx:
  ds_read_b128 v[96:99], v4
  v_add_u32 v4, 1024, v4
  s_waitcnt lgkmcnt(0)
  v_mfma_f32_32x32x16_bf16 v[16:31], v[96:99], v[120:123], 0
  s_nop 11
  v_max3_f32 v3, v3, v16, v17
  v_max3_f32 v3, v3, v18, v19
  v_max3_f32 v3, v3, v20, v21
  v_max3_f32 v3, v3, v22, v23
  v_max3_f32 v3, v3, v24, v25
  v_max3_f32 v3, v3, v26, v27
  v_max3_f32 v3, v3, v28, v29
  v_max3_f32 v3, v3, v30, v31
  s_sub_u32 s50, s50, 1
  s_cmp_lg_u32 s50, 0
  s_cbranch_scc1 .Lk2_mx
  v_xor_b32 v4, 32, v0
  v_lshlrev_b32 v4, 2, v4
  ds_bpermute_b32 v5, v4, v3
  s_waitcnt lgkmcnt(0)
  v_max_f32 v3, v3, v5
  v_sub_f32 v64, 0, v3
  v_sub_f32 v65, 0, v3
  v_sub_f32 v66, 0, v3
  v_sub_f32 v67, 0, v3
  v_sub_f32 v68, 0, v3
  v_sub_f32 v69, 0, v3
  v_sub_f32 v70, 0, v3
  v_sub_f32 v71, 0, v3
  v_sub_f32 v72, 0, v3
  v_sub_f32 v73, 0, v3
  v_sub_f32 v74, 0, v3
  v_sub_f32 v75, 0, v3
  v_sub_f32 v76, 0, v3
  v_sub_f32 v77, 0, v3
  v_sub_f32 v78, 0, v3
  v_sub_f32 v79, 0, v3
  s_branch .Lk2_main
.Lk2_fin:
  s_waitcnt vmcnt(0)
  v_rcp_f32 v3, v56
  s_add_u32 s44, s44, 5242880
  v_mul_f32 v48, v3, v48
  v_mul_f32 v49, v3, v49
  v_mul_f32 v50, v3, v50
  v_mul_f32 v51, v3, v51
  v_mul_f32 v52, v3, v52
  v_mul_f32 v53, v3, v53
  v_mul_f32 v54, v3, v54
  v_mul_f32 v55, v3, v55
  v_cvt_pk_bf16_f32 v4, v48, v49
  v_cvt_pk_bf16_f32 v5, v50, v51
  v_cvt_pk_bf16_f32 v6, v52, v53
  v_cvt_pk_bf16_f32 v7, v54, v55
  buffer_store_dwordx4 v[4:7], v1, s[24:27], s44 offen sc1
  s_waitcnt vmcnt(0)
  s_barrier
  s_setprio 0
  s_cmp_lg_u32 s3, 0
  s_cbranch_scc1 .Lk3_na
  s_lshl_b32 s50, s40, 1
  s_lshr_b32 s51, s41, 4
  s_add_u32 s50, s50, s51
  s_lshl_b32 s50, s50, 12
  s_add_u32 s50, s50, 11534336
  v_mov_b32 v2, 1
  v_lshlrev_b32 v3, 9, v0
  s_mov_b64 exec, 0xff
  buffer_atomic_add v2, v3, s[24:27], s50 offen sc1
  s_mov_b64 exec, -1
.Lk3_na:
  s_mov_b32 s71, s3
  s_and_b32 s3, s3, 3
  s_lshr_b32 s45, s41, 3
  s_and_b32 s45, s45, 1
  s_lshl_b32 s46, s40, 1
  s_add_u32 s45, s45, s46
  s_and_b32 s44, s41, 7
  s_lshr_b32 s42, s3, 1
  s_and_b32 s43, s3, 1
  s_lshl_b32 s47, s3, 10
  v_lshlrev_b32 v9, 4, v0
  s_mov_b32 s28, s20
  s_mov_b32 s29, s21
  s_mov_b32 s30, 4194304
  s_mov_b32 s31, 0x00020000
  s_cmp_ge_u32 s41, 16
  s_cbranch_scc1 .Lk3_z
  s_mov_b32 s32, s12
  s_mov_b32 s33, s13
  s_mov_b32 s34, 524288
  s_mov_b32 s35, 0x00020000
  s_lshl_b32 s50, s45, 17
  s_add_u32 s50, s50, s47
  v_add_u32 v10, s50, v9
  v_lshrrev_b32 v2, 3, v0
  v_and_b32 v3, 7, v0
  v_lshrrev_b32 v4, 4, v0
  v_and_b32 v4, 1, v4
  v_lshlrev_b32 v4, 2, v4
  v_xor_b32 v3, v3, v4
  v_lshlrev_b32 v3, 4, v3
  v_lshl_add_u32 v11, v2, 10, v3
  s_lshl_b32 s50, s44, 7
  s_lshl_b32 s51, s3, 13
  s_add_u32 s50, s50, s51
  v_add_u32 v11, s50, v11
  v_lshrrev_b32 v2, 2, v0
  v_and_b32 v2, 3, v2
  v_lshrrev_b32 v3, 5, v0
  v_lshlrev_b32 v4, 2, v3
  v_add_u32 v4, v4, v2
  v_lshlrev_b32 v13, 7, v4
  v_lshrrev_b32 v2, 1, v2
  v_xor_b32 v2, s43, v2
  v_lshl_add_u32 v13, v2, 6, v13
  v_bfe_u32 v4, v0, 4, 1
  v_and_b32 v5, 3, v0
  v_and_b32 v6, 1, v5
  v_lshrrev_b32 v5, 1, v5
  v_lshl_add_u32 v5, v6, 2, v5
  v_lshl_add_u32 v5, v4, 1, v5
  v_lshl_add_u32 v13, v5, 3, v13
  s_lshl_b32 s50, s42, 13
  v_add_u32 v14, s50, v9
  s_mov_b32 s49, 0
  s_cmp_lt_u32 s71, 4
  s_cbranch_scc1 .Lk3_co
  s_mov_b32 s52, 0
  s_add_u32 m0, s47, 98304
  s_nop 0
  buffer_load_dwordx4 v11, s[32:35], s52 offen lds
  s_mov_b32 s52, 32768
  s_add_u32 m0, s47, 102400
  s_nop 0
  buffer_load_dwordx4 v11, s[32:35], s52 offen lds
  s_mov_b32 s52, 65536
  s_add_u32 m0, s47, 106496
  s_nop 0
  buffer_load_dwordx4 v11, s[32:35], s52 offen lds
  s_mov_b32 s52, 98304
  s_add_u32 m0, s47, 110592
  s_nop 0
  buffer_load_dwordx4 v11, s[32:35], s52 offen lds
  s_mov_b32 s52, 131072
  s_add_u32 m0, s47, 114688
  s_nop 0
  buffer_load_dwordx4 v11, s[32:35], s52 offen lds
  s_mov_b32 s52, 163840
  s_add_u32 m0, s47, 118784
  s_nop 0
  buffer_load_dwordx4 v11, s[32:35], s52 offen lds
  s_mov_b32 s52, 196608
  s_add_u32 m0, s47, 122880
  s_nop 0
  buffer_load_dwordx4 v11, s[32:35], s52 offen lds
  s_mov_b32 s52, 229376
  s_add_u32 m0, s47, 126976
  s_nop 0
  buffer_load_dwordx4 v11, s[32:35], s52 offen lds
  s_mov_b32 s52, 262144
  s_add_u32 m0, s47, 131072
  s_nop 0
  buffer_load_dwordx4 v11, s[32:35], s52 offen lds
  s_mov_b32 s52, 294912
  s_add_u32 m0, s47, 135168
  s_nop 0
  buffer_load_dwordx4 v11, s[32:35], s52 offen lds
  s_mov_b32 s52, 327680
  s_add_u32 m0, s47, 139264
  s_nop 0
  buffer_load_dwordx4 v11, s[32:35], s52 offen lds
  s_mov_b32 s52, 360448
  s_add_u32 m0, s47, 143360
  s_nop 0
  buffer_load_dwordx4 v11, s[32:35], s52 offen lds
  s_mov_b32 s52, 393216
  s_add_u32 m0, s47, 147456
  s_nop 0
  buffer_load_dwordx4 v11, s[32:35], s52 offen lds
  s_mov_b32 s52, 425984
  s_add_u32 m0, s47, 151552
  s_nop 0
  buffer_load_dwordx4 v11, s[32:35], s52 offen lds
  s_mov_b32 s52, 458752
  s_add_u32 m0, s47, 155648
  s_nop 0
  buffer_load_dwordx4 v11, s[32:35], s52 offen lds
  s_mov_b32 s52, 491520
  s_add_u32 m0, s47, 159744
  s_nop 0
  buffer_load_dwordx4 v11, s[32:35], s52 offen lds
  s_waitcnt vmcnt(0)
  s_barrier
  s_mov_b32 s3, s71
  s_branch .Lfin_k2_kernel
.Lk3_co:
  s_cmp_lg_u32 s71, 0
  s_cbranch_scc1 .Lk3_bo
  s_mov_b32 s50, 11534336
  s_mov_b32 s51, 0x40000
  s_lshl_b32 s52, s45, 3
  s_add_u32 s52, s52, s44
  s_lshl_b32 s52, s52, 9
  v_mov_b32 v2, s52
.Lk3_po:
  buffer_load_dword v3, v2, s[24:27], s50 offen sc1
  s_sub_u32 s51, s51, 1
  s_cbranch_scc1 .Lk3_bo
  s_waitcnt vmcnt(0)
  v_cmp_gt_u32 vcc, 16, v3
  s_cbranch_vccnz .Lk3_po
.Lk3_bo:
  s_waitcnt vmcnt(0)
  s_barrier
  s_mov_b32 s52, 5242880
  s_add_u32 m0, s47, 0
  s_nop 0
  buffer_load_dwordx4 v10, s[24:27], s52 offen lds
  s_mov_b32 s52, 5275648
  s_add_u32 m0, s47, 4096
  s_nop 0
  buffer_load_dwordx4 v10, s[24:27], s52 offen lds
  s_mov_b32 s52, 5308416
  s_add_u32 m0, s47, 8192
  s_nop 0
  buffer_load_dwordx4 v10, s[24:27], s52 offen lds
  s_mov_b32 s52, 5341184
  s_add_u32 m0, s47, 12288
  s_nop 0
  buffer_load_dwordx4 v10, s[24:27], s52 offen lds
  s_mov_b32 s52, 5246976
  s_add_u32 m0, s47, 16384
  s_nop 0
  buffer_load_dwordx4 v10, s[24:27], s52 offen lds
  s_mov_b32 s52, 5279744
  s_add_u32 m0, s47, 20480
  s_nop 0
  buffer_load_dwordx4 v10, s[24:27], s52 offen lds
  s_mov_b32 s52, 5312512
  s_add_u32 m0, s47, 24576
  s_nop 0
  buffer_load_dwordx4 v10, s[24:27], s52 offen lds
  s_mov_b32 s52, 5345280
  s_add_u32 m0, s47, 28672
  s_nop 0
  buffer_load_dwordx4 v10, s[24:27], s52 offen lds
  s_mov_b32 s52, 5251072
  s_add_u32 m0, s47, 32768
  s_nop 0
  buffer_load_dwordx4 v10, s[24:27], s52 offen lds
  s_mov_b32 s52, 5283840
  s_add_u32 m0, s47, 36864
  s_nop 0
  buffer_load_dwordx4 v10, s[24:27], s52 offen lds
  s_mov_b32 s52, 5316608
  s_add_u32 m0, s47, 40960
  s_nop 0
  buffer_load_dwordx4 v10, s[24:27], s52 offen lds
  s_mov_b32 s52, 5349376
  s_add_u32 m0, s47, 45056
  s_nop 0
  buffer_load_dwordx4 v10, s[24:27], s52 offen lds
  s_mov_b32 s52, 5255168
  s_add_u32 m0, s47, 49152
  s_nop 0
  buffer_load_dwordx4 v10, s[24:27], s52 offen lds
  s_mov_b32 s52, 5287936
  s_add_u32 m0, s47, 53248
  s_nop 0
  buffer_load_dwordx4 v10, s[24:27], s52 offen lds
  s_mov_b32 s52, 5320704
  s_add_u32 m0, s47, 57344
  s_nop 0
  buffer_load_dwordx4 v10, s[24:27], s52 offen lds
  s_mov_b32 s52, 5353472
  s_add_u32 m0, s47, 61440
  s_nop 0
  buffer_load_dwordx4 v10, s[24:27], s52 offen lds
  s_mov_b32 s52, 5259264
  s_add_u32 m0, s47, 65536
  s_nop 0
  buffer_load_dwordx4 v10, s[24:27], s52 offen lds
  s_mov_b32 s52, 5292032
  s_add_u32 m0, s47, 69632
  s_nop 0
  buffer_load_dwordx4 v10, s[24:27], s52 offen lds
  s_mov_b32 s52, 5324800
  s_add_u32 m0, s47, 73728
  s_nop 0
  buffer_load_dwordx4 v10, s[24:27], s52 offen lds
  s_mov_b32 s52, 5357568
  s_add_u32 m0, s47, 77824
  s_nop 0
  buffer_load_dwordx4 v10, s[24:27], s52 offen lds
  s_mov_b32 s52, 5263360
  s_add_u32 m0, s47, 81920
  s_nop 0
  buffer_load_dwordx4 v10, s[24:27], s52 offen lds
  s_mov_b32 s52, 5296128
  s_add_u32 m0, s47, 86016
  s_nop 0
  buffer_load_dwordx4 v10, s[24:27], s52 offen lds
  s_mov_b32 s52, 5328896
  s_add_u32 m0, s47, 90112
  s_nop 0
  buffer_load_dwordx4 v10, s[24:27], s52 offen lds
  s_mov_b32 s52, 5361664
  s_add_u32 m0, s47, 94208
  s_nop 0
  buffer_load_dwordx4 v10, s[24:27], s52 offen lds
  s_waitcnt vmcnt(20) lgkmcnt(0)
  s_barrier
  v_add_u32 v16, 0, v14
  v_add_u32 v17, 98304, v13
  ds_read_b64_tr_b16 v[64:65], v17 offset:0
  ds_read_b64_tr_b16 v[66:67], v17 offset:1024
  ds_read_b128 v[68:71], v16 offset:0
  ds_read_b128 v[72:75], v16 offset:4096
  ds_read_b64_tr_b16 v[76:77], v17 offset:2048
  ds_read_b64_tr_b16 v[78:79], v17 offset:3072
  ds_read_b128 v[80:83], v16 offset:1024
  ds_read_b128 v[84:87], v16 offset:5120
  ds_read_b64_tr_b16 v[88:89], v17 offset:4096
  ds_read_b64_tr_b16 v[90:91], v17 offset:5120
  ds_read_b128 v[92:95], v16 offset:2048
  ds_read_b128 v[96:99], v16 offset:6144
  ds_read_b64_tr_b16 v[100:101], v17 offset:6144
  ds_read_b64_tr_b16 v[102:103], v17 offset:7168
  ds_read_b128 v[104:107], v16 offset:3072
  ds_read_b128 v[108:111], v16 offset:7168
  s_waitcnt vmcnt(16) lgkmcnt(0)
  s_barrier
  v_add_u32 v16, 16384, v14
  v_add_u32 v17, 106496, v13
  ds_read_b64_tr_b16 v[112:113], v17 offset:0
  ds_read_b64_tr_b16 v[114:115], v17 offset:1024
  ds_read_b128 v[116:119], v16 offset:0
  ds_read_b128 v[120:123], v16 offset:4096
  v_mfma_f32_32x32x16_bf16 v[32:47], v[64:67], v[68:71], 0
  v_mfma_f32_32x32x16_bf16 v[48:63], v[64:67], v[72:75], 0
  s_mov_b32 s52, 5267456
  s_add_u32 m0, s47, 0
  s_nop 0
  buffer_load_dwordx4 v10, s[24:27], s52 offen lds
  ds_read_b64_tr_b16 v[124:125], v17 offset:2048
  ds_read_b64_tr_b16 v[126:127], v17 offset:3072
  ds_read_b128 v[128:131], v16 offset:1024
  ds_read_b128 v[132:135], v16 offset:5120
  v_mfma_f32_32x32x16_bf16 v[32:47], v[76:79], v[80:83], v[32:47]
  v_mfma_f32_32x32x16_bf16 v[48:63], v[76:79], v[84:87], v[48:63]
  s_mov_b32 s52, 5300224
  s_add_u32 m0, s47, 4096
  s_nop 0
  buffer_load_dwordx4 v10, s[24:27], s52 offen lds
  ds_read_b64_tr_b16 v[136:137], v17 offset:4096
  ds_read_b64_tr_b16 v[138:139], v17 offset:5120
  ds_read_b128 v[140:143], v16 offset:2048
  ds_read_b128 v[144:147], v16 offset:6144
  v_mfma_f32_32x32x16_bf16 v[32:47], v[88:91], v[92:95], v[32:47]
  v_mfma_f32_32x32x16_bf16 v[48:63], v[88:91], v[96:99], v[48:63]
  s_mov_b32 s52, 5332992
  s_add_u32 m0, s47, 8192
  s_nop 0
  buffer_load_dwordx4 v10, s[24:27], s52 offen lds
  ds_read_b64_tr_b16 v[148:149], v17 offset:6144
  ds_read_b64_tr_b16 v[150:151], v17 offset:7168
  ds_read_b128 v[152:155], v16 offset:3072
  ds_read_b128 v[156:159], v16 offset:7168
  v_mfma_f32_32x32x16_bf16 v[32:47], v[100:103], v[104:107], v[32:47]
  v_mfma_f32_32x32x16_bf16 v[48:63], v[100:103], v[108:111], v[48:63]
  s_mov_b32 s52, 5365760
  s_add_u32 m0, s47, 12288
  s_nop 0
  buffer_load_dwordx4 v10, s[24:27], s52 offen lds
  s_waitcnt vmcnt(16) lgkmcnt(0)
  s_barrier
  v_add_u32 v16, 32768, v14
  v_add_u32 v17, 114688, v13
  ds_read_b64_tr_b16 v[64:65], v17 offset:0
  ds_read_b64_tr_b16 v[66:67], v17 offset:1024
  ds_read_b128 v[68:71], v16 offset:0
  ds_read_b128 v[72:75], v16 offset:4096
  v_mfma_f32_32x32x16_bf16 v[32:47], v[112:115], v[116:119], v[32:47]
  v_mfma_f32_32x32x16_bf16 v[48:63], v[112:115], v[120:123], v[48:63]
  s_mov_b32 s52, 5271552
  s_add_u32 m0, s47, 16384
  s_nop 0
  buffer_load_dwordx4 v10, s[24:27], s52 offen lds
  ds_read_b64_tr_b16 v[76:77], v17 offset:2048
  ds_read_b64_tr_b16 v[78:79], v17 offset:3072
  ds_read_b128 v[80:83], v16 offset:1024
  ds_read_b128 v[84:87], v16 offset:5120
  v_mfma_f32_32x32x16_bf16 v[32:47], v[124:127], v[128:131], v[32:47]
  v_mfma_f32_32x32x16_bf16 v[48:63], v[124:127], v[132:135], v[48:63]
  s_mov_b32 s52, 5304320
  s_add_u32 m0, s47, 20480
  s_nop 0
  buffer_load_dwordx4 v10, s[24:27], s52 offen lds
  ds_read_b64_tr_b16 v[88:89], v17 offset:4096
  ds_read_b64_tr_b16 v[90:91], v17 offset:5120
  ds_read_b128 v[92:95], v16 offset:2048
  ds_read_b128 v[96:99], v16 offset:6144
  v_mfma_f32_32x32x16_bf16 v[32:47], v[136:139], v[140:143], v[32:47]
  v_mfma_f32_32x32x16_bf16 v[48:63], v[136:139], v[144:147], v[48:63]
  s_mov_b32 s52, 5337088
  s_add_u32 m0, s47, 24576
  s_nop 0
  buffer_load_dwordx4 v10, s[24:27], s52 offen lds
  ds_read_b64_tr_b16 v[100:101], v17 offset:6144
  ds_read_b64_tr_b16 v[102:103], v17 offset:7168
  ds_read_b128 v[104:107], v16 offset:3072
  ds_read_b128 v[108:111], v16 offset:7168
  v_mfma_f32_32x32x16_bf16 v[32:47], v[148:151], v[152:155], v[32:47]
  v_mfma_f32_32x32x16_bf16 v[48:63], v[148:151], v[156:159], v[48:63]
  s_mov_b32 s52, 5369856
  s_add_u32 m0, s47, 28672
  s_nop 0
  buffer_load_dwordx4 v10, s[24:27], s52 offen lds
  s_waitcnt vmcnt(16) lgkmcnt(0)
  s_barrier
  v_add_u32 v16, 49152, v14
  v_add_u32 v17, 122880, v13
  ds_read_b64_tr_b16 v[112:113], v17 offset:0
  ds_read_b64_tr_b16 v[114:115], v17 offset:1024
  ds_read_b128 v[116:119], v16 offset:0
  ds_read_b128 v[120:123], v16 offset:4096
  v_mfma_f32_32x32x16_bf16 v[32:47], v[64:67], v[68:71], v[32:47]
  v_mfma_f32_32x32x16_bf16 v[48:63], v[64:67], v[72:75], v[48:63]
  ds_read_b64_tr_b16 v[124:125], v17 offset:2048
  ds_read_b64_tr_b16 v[126:127], v17 offset:3072
  ds_read_b128 v[128:131], v16 offset:1024
  ds_read_b128 v[132:135], v16 offset:5120
  v_mfma_f32_32x32x16_bf16 v[32:47], v[76:79], v[80:83], v[32:47]
  v_mfma_f32_32x32x16_bf16 v[48:63], v[76:79], v[84:87], v[48:63]
  ds_read_b64_tr_b16 v[136:137], v17 offset:4096
  ds_read_b64_tr_b16 v[138:139], v17 offset:5120
  ds_read_b128 v[140:143], v16 offset:2048
  ds_read_b128 v[144:147], v16 offset:6144
  v_mfma_f32_32x32x16_bf16 v[32:47], v[88:91], v[92:95], v[32:47]
  v_mfma_f32_32x32x16_bf16 v[48:63], v[88:91], v[96:99], v[48:63]
  ds_read_b64_tr_b16 v[148:149], v17 offset:6144
  ds_read_b64_tr_b16 v[150:151], v17 offset:7168
  ds_read_b128 v[152:155], v16 offset:3072
  ds_read_b128 v[156:159], v16 offset:7168
  v_mfma_f32_32x32x16_bf16 v[32:47], v[100:103], v[104:107], v[32:47]
  v_mfma_f32_32x32x16_bf16 v[48:63], v[100:103], v[108:111], v[48:63]
  s_waitcnt vmcnt(12) lgkmcnt(0)
  s_barrier
  v_add_u32 v16, 65536, v14
  v_add_u32 v17, 131072, v13
  ds_read_b64_tr_b16 v[64:65], v17 offset:0
  ds_read_b64_tr_b16 v[66:67], v17 offset:1024
  ds_read_b128 v[68:71], v16 offset:0
  ds_read_b128 v[72:75], v16 offset:4096
  v_mfma_f32_32x32x16_bf16 v[32:47], v[112:115], v[116:119], v[32:47]
  v_mfma_f32_32x32x16_bf16 v[48:63], v[112:115], v[120:123], v[48:63]
  ds_read_b64_tr_b16 v[76:77], v17 offset:2048
  ds_read_b64_tr_b16 v[78:79], v17 offset:3072
  ds_read_b128 v[80:83], v16 offset:1024
  ds_read_b128 v[84:87], v16 offset:5120
  v_mfma_f32_32x32x16_bf16 v[32:47], v[124:127], v[128:131], v[32:47]
  v_mfma_f32_32x32x16_bf16 v[48:63], v[124:127], v[132:135], v[48:63]
  ds_read_b64_tr_b16 v[88:89], v17 offset:4096
  ds_read_b64_tr_b16 v[90:91], v17 offset:5120
  ds_read_b128 v[92:95], v16 offset:2048
  ds_read_b128 v[96:99], v16 offset:6144
  v_mfma_f32_32x32x16_bf16 v[32:47], v[136:139], v[140:143], v[32:47]
  v_mfma_f32_32x32x16_bf16 v[48:63], v[136:139], v[144:147], v[48:63]
  ds_read_b64_tr_b16 v[100:101], v17 offset:6144
  ds_read_b64_tr_b16 v[102:103], v17 offset:7168
  ds_read_b128 v[104:107], v16 offset:3072
  ds_read_b128 v[108:111], v16 offset:7168
  v_mfma_f32_32x32x16_bf16 v[32:47], v[148:151], v[152:155], v[32:47]
  v_mfma_f32_32x32x16_bf16 v[48:63], v[148:151], v[156:159], v[48:63]
  s_waitcnt vmcnt(8) lgkmcnt(0)
  s_barrier
  v_add_u32 v16, 81920, v14
  v_add_u32 v17, 139264, v13
  ds_read_b64_tr_b16 v[112:113], v17 offset:0
  ds_read_b64_tr_b16 v[114:115], v17 offset:1024
  ds_read_b128 v[116:119], v16 offset:0
  ds_read_b128 v[120:123], v16 offset:4096
  v_mfma_f32_32x32x16_bf16 v[32:47], v[64:67], v[68:71], v[32:47]
  v_mfma_f32_32x32x16_bf16 v[48:63], v[64:67], v[72:75], v[48:63]
  ds_read_b64_tr_b16 v[124:125], v17 offset:2048
  ds_read_b64_tr_b16 v[126:127], v17 offset:3072
  ds_read_b128 v[128:131], v16 offset:1024
  ds_read_b128 v[132:135], v16 offset:5120
  v_mfma_f32_32x32x16_bf16 v[32:47], v[76:79], v[80:83], v[32:47]
  v_mfma_f32_32x32x16_bf16 v[48:63], v[76:79], v[84:87], v[48:63]
  ds_read_b64_tr_b16 v[136:137], v17 offset:4096
  ds_read_b64_tr_b16 v[138:139], v17 offset:5120
  ds_read_b128 v[140:143], v16 offset:2048
  ds_read_b128 v[144:147], v16 offset:6144
  v_mfma_f32_32x32x16_bf16 v[32:47], v[88:91], v[92:95], v[32:47]
  v_mfma_f32_32x32x16_bf16 v[48:63], v[88:91], v[96:99], v[48:63]
  ds_read_b64_tr_b16 v[148:149], v17 offset:6144
  ds_read_b64_tr_b16 v[150:151], v17 offset:7168
  ds_read_b128 v[152:155], v16 offset:3072
  ds_read_b128 v[156:159], v16 offset:7168
  v_mfma_f32_32x32x16_bf16 v[32:47], v[100:103], v[104:107], v[32:47]
  v_mfma_f32_32x32x16_bf16 v[48:63], v[100:103], v[108:111], v[48:63]
  s_waitcnt vmcnt(4) lgkmcnt(0)
  s_barrier
  v_add_u32 v16, 0, v14
  v_add_u32 v17, 147456, v13
  ds_read_b64_tr_b16 v[64:65], v17 offset:0
  ds_read_b64_tr_b16 v[66:67], v17 offset:1024
  ds_read_b128 v[68:71], v16 offset:0
  ds_read_b128 v[72:75], v16 offset:4096
  v_mfma_f32_32x32x16_bf16 v[32:47], v[112:115], v[116:119], v[32:47]
  v_mfma_f32_32x32x16_bf16 v[48:63], v[112:115], v[120:123], v[48:63]
  ds_read_b64_tr_b16 v[76:77], v17 offset:2048
  ds_read_b64_tr_b16 v[78:79], v17 offset:3072
  ds_read_b128 v[80:83], v16 offset:1024
  ds_read_b128 v[84:87], v16 offset:5120
  v_mfma_f32_32x32x16_bf16 v[32:47], v[124:127], v[128:131], v[32:47]
  v_mfma_f32_32x32x16_bf16 v[48:63], v[124:127], v[132:135], v[48:63]
  ds_read_b64_tr_b16 v[88:89], v17 offset:4096
  ds_read_b64_tr_b16 v[90:91], v17 offset:5120
  ds_read_b128 v[92:95], v16 offset:2048
  ds_read_b128 v[96:99], v16 offset:6144
  v_mfma_f32_32x32x16_bf16 v[32:47], v[136:139], v[140:143], v[32:47]
  v_mfma_f32_32x32x16_bf16 v[48:63], v[136:139], v[144:147], v[48:63]
  ds_read_b64_tr_b16 v[100:101], v17 offset:6144
  ds_read_b64_tr_b16 v[102:103], v17 offset:7168
  ds_read_b128 v[104:107], v16 offset:3072
  ds_read_b128 v[108:111], v16 offset:7168
  v_mfma_f32_32x32x16_bf16 v[32:47], v[148:151], v[152:155], v[32:47]
  v_mfma_f32_32x32x16_bf16 v[48:63], v[148:151], v[156:159], v[48:63]
  s_waitcnt vmcnt(0) lgkmcnt(0)
  s_barrier
  v_add_u32 v16, 16384, v14
  v_add_u32 v17, 155648, v13
  ds_read_b64_tr_b16 v[112:113], v17 offset:0
  ds_read_b64_tr_b16 v[114:115], v17 offset:1024
  ds_read_b128 v[116:119], v16 offset:0
  ds_read_b128 v[120:123], v16 offset:4096
  v_mfma_f32_32x32x16_bf16 v[32:47], v[64:67], v[68:71], v[32:47]
  v_mfma_f32_32x32x16_bf16 v[48:63], v[64:67], v[72:75], v[48:63]
  ds_read_b64_tr_b16 v[124:125], v17 offset:2048
  ds_read_b64_tr_b16 v[126:127], v17 offset:3072
  ds_read_b128 v[128:131], v16 offset:1024
  ds_read_b128 v[132:135], v16 offset:5120
  v_mfma_f32_32x32x16_bf16 v[32:47], v[76:79], v[80:83], v[32:47]
  v_mfma_f32_32x32x16_bf16 v[48:63], v[76:79], v[84:87], v[48:63]
  ds_read_b64_tr_b16 v[136:137], v17 offset:4096
  ds_read_b64_tr_b16 v[138:139], v17 offset:5120
  ds_read_b128 v[140:143], v16 offset:2048
  ds_read_b128 v[144:147], v16 offset:6144
  v_mfma_f32_32x32x16_bf16 v[32:47], v[88:91], v[92:95], v[32:47]
  v_mfma_f32_32x32x16_bf16 v[48:63], v[88:91], v[96:99], v[48:63]
  ds_read_b64_tr_b16 v[148:149], v17 offset:6144
  ds_read_b64_tr_b16 v[150:151], v17 offset:7168
  ds_read_b128 v[152:155], v16 offset:3072
  ds_read_b128 v[156:159], v16 offset:7168
  v_mfma_f32_32x32x16_bf16 v[32:47], v[100:103], v[104:107], v[32:47]
  v_mfma_f32_32x32x16_bf16 v[48:63], v[100:103], v[108:111], v[48:63]
  s_waitcnt lgkmcnt(12)
  v_mfma_f32_32x32x16_bf16 v[32:47], v[112:115], v[116:119], v[32:47]
  v_mfma_f32_32x32x16_bf16 v[48:63], v[112:115], v[120:123], v[48:63]
  s_waitcnt lgkmcnt(8)
  v_mfma_f32_32x32x16_bf16 v[32:47], v[124:127], v[128:131], v[32:47]
  v_mfma_f32_32x32x16_bf16 v[48:63], v[124:127], v[132:135], v[48:63]
  s_waitcnt lgkmcnt(4)
  v_mfma_f32_32x32x16_bf16 v[32:47], v[136:139], v[140:143], v[32:47]
  v_mfma_f32_32x32x16_bf16 v[48:63], v[136:139], v[144:147], v[48:63]
  s_waitcnt lgkmcnt(0)
  v_mfma_f32_32x32x16_bf16 v[32:47], v[148:151], v[152:155], v[32:47]
  v_mfma_f32_32x32x16_bf16 v[48:63], v[148:151], v[156:159], v[48:63]
  s_branch .Lk3_epi
.Lk3_z:
  v_lshrrev_b32 v2, 4, v0
  v_lshlrev_b32 v3, 2, v2
  v_and_b32 v4, 15, v0
  v_xor_b32 v3, v3, v4
  v_lshlrev_b32 v3, 4, v3
  s_lshl_b32 s50, s3, 2
  v_add_u32 v2, s50, v2
  v_mul_u32_u24 v2, 4352, v2
  v_add_u32 v10, v2, v3
  s_lshl_b32 s50, s45, 8
  v_add_u32 v10, s50, v10
  s_lshl_b32 s50, s44, 16
  s_add_u32 s50, s50, s47
  v_add_u32 v11, s50, v9
  v_bfe_u32 v2, v0, 2, 2
  v_lshrrev_b32 v3, 5, v0
  v_lshl_add_u32 v3, v3, 3, v2
  v_lshlrev_b32 v3, 8, v3
  v_bfe_u32 v4, v0, 4, 1
  v_lshl_add_u32 v3, v4, 5, v3
  v_and_b32 v4, 3, v0
  v_lshl_add_u32 v3, v4, 3, v3
  s_lshl_b32 s50, s42, 1
  v_xor_b32 v4, s50, v2
  v_lshl_add_u32 v14, v4, 6, v3
  v_xor_b32 v15, 64, v14
  s_lshl_b32 s50, s43, 12
  v_add_u32 v13, s50, v9
  s_mov_b32 s49, 1024
  s_cmp_lt_u32 s71, 4
  s_cbranch_scc1 .Lk3_cz
  s_mov_b32 s52, 9437184
  s_add_u32 m0, s47, 98304
  s_nop 0
  buffer_load_dwordx4 v11, s[24:27], s52 offen lds
  s_mov_b32 s52, 9469952
  s_add_u32 m0, s47, 102400
  s_nop 0
  buffer_load_dwordx4 v11, s[24:27], s52 offen lds
  s_mov_b32 s52, 9441280
  s_add_u32 m0, s47, 106496
  s_nop 0
  buffer_load_dwordx4 v11, s[24:27], s52 offen lds
  s_mov_b32 s52, 9474048
  s_add_u32 m0, s47, 110592
  s_nop 0
  buffer_load_dwordx4 v11, s[24:27], s52 offen lds
  s_mov_b32 s52, 9445376
  s_add_u32 m0, s47, 114688
  s_nop 0
  buffer_load_dwordx4 v11, s[24:27], s52 offen lds
  s_mov_b32 s52, 9478144
  s_add_u32 m0, s47, 118784
  s_nop 0
  buffer_load_dwordx4 v11, s[24:27], s52 offen lds
  s_mov_b32 s52, 9449472
  s_add_u32 m0, s47, 122880
  s_nop 0
  buffer_load_dwordx4 v11, s[24:27], s52 offen lds
  s_mov_b32 s52, 9482240
  s_add_u32 m0, s47, 126976
  s_nop 0
  buffer_load_dwordx4 v11, s[24:27], s52 offen lds
  s_mov_b32 s52, 9453568
  s_add_u32 m0, s47, 131072
  s_nop 0
  buffer_load_dwordx4 v11, s[24:27], s52 offen lds
  s_mov_b32 s52, 9486336
  s_add_u32 m0, s47, 135168
  s_nop 0
  buffer_load_dwordx4 v11, s[24:27], s52 offen lds
  s_mov_b32 s52, 9457664
  s_add_u32 m0, s47, 139264
  s_nop 0
  buffer_load_dwordx4 v11, s[24:27], s52 offen lds
  s_mov_b32 s52, 9490432
  s_add_u32 m0, s47, 143360
  s_nop 0
  buffer_load_dwordx4 v11, s[24:27], s52 offen lds
  s_mov_b32 s52, 9461760
  s_add_u32 m0, s47, 147456
  s_nop 0
  buffer_load_dwordx4 v11, s[24:27], s52 offen lds
  s_mov_b32 s52, 9494528
  s_add_u32 m0, s47, 151552
  s_nop 0
  buffer_load_dwordx4 v11, s[24:27], s52 offen lds
  s_mov_b32 s52, 9465856
  s_add_u32 m0, s47, 155648
  s_nop 0
  buffer_load_dwordx4 v11, s[24:27], s52 offen lds
  s_mov_b32 s52, 9498624
  s_add_u32 m0, s47, 159744
  s_nop 0
  buffer_load_dwordx4 v11, s[24:27], s52 offen lds
  s_waitcnt vmcnt(0)
  s_barrier
  s_mov_b32 s3, s71
  s_branch .Lfin_k2_kernel
.Lk3_cz:
  s_cmp_lg_u32 s71, 0
  s_cbranch_scc1 .Lk3_bz
  s_mov_b32 s50, 11534592
  s_mov_b32 s51, 0x40000
  v_and_b32 v2, 15, v0
  v_lshlrev_b32 v2, 9, v2
.Lk3_pz:
  buffer_load_dword v3, v2, s[24:27], s50 offen sc1
  s_sub_u32 s51, s51, 1
  s_cbranch_scc1 .Lk3_bz
  s_waitcnt vmcnt(0)
  v_cmp_gt_u32 vcc, 64, v3
  s_cbranch_vccnz .Lk3_pz
.Lk3_bz:
  s_waitcnt vmcnt(0)
  s_barrier
  s_mov_b32 s52, 16777216
  s_add_u32 m0, s47, 0
  s_nop 0
  buffer_load_dwordx4 v10, s[24:27], s52 offen lds
  s_mov_b32 s52, 16846848
  s_add_u32 m0, s47, 4096
  s_nop 0
  buffer_load_dwordx4 v10, s[24:27], s52 offen lds
  s_mov_b32 s52, 16916480
  s_add_u32 m0, s47, 8192
  s_nop 0
  buffer_load_dwordx4 v10, s[24:27], s52 offen lds
  s_mov_b32 s52, 16986112
  s_add_u32 m0, s47, 12288
  s_nop 0
  buffer_load_dwordx4 v10, s[24:27], s52 offen lds
  s_mov_b32 s52, 17055744
  s_add_u32 m0, s47, 16384
  s_nop 0
  buffer_load_dwordx4 v10, s[24:27], s52 offen lds
  s_mov_b32 s52, 17125376
  s_add_u32 m0, s47, 20480
  s_nop 0
  buffer_load_dwordx4 v10, s[24:27], s52 offen lds
  s_mov_b32 s52, 17195008
  s_add_u32 m0, s47, 24576
  s_nop 0
  buffer_load_dwordx4 v10, s[24:27], s52 offen lds
  s_mov_b32 s52, 17264640
  s_add_u32 m0, s47, 28672
  s_nop 0
  buffer_load_dwordx4 v10, s[24:27], s52 offen lds
  s_mov_b32 s52, 17334272
  s_add_u32 m0, s47, 32768
  s_nop 0
  buffer_load_dwordx4 v10, s[24:27], s52 offen lds
  s_mov_b32 s52, 17403904
  s_add_u32 m0, s47, 36864
  s_nop 0
  buffer_load_dwordx4 v10, s[24:27], s52 offen lds
  s_mov_b32 s52, 17473536
  s_add_u32 m0, s47, 40960
  s_nop 0
  buffer_load_dwordx4 v10, s[24:27], s52 offen lds
  s_mov_b32 s52, 17543168
  s_add_u32 m0, s47, 45056
  s_nop 0
  buffer_load_dwordx4 v10, s[24:27], s52 offen lds
  s_mov_b32 s52, 17612800
  s_add_u32 m0, s47, 49152
  s_nop 0
  buffer_load_dwordx4 v10, s[24:27], s52 offen lds
  s_mov_b32 s52, 17682432
  s_add_u32 m0, s47, 53248
  s_nop 0
  buffer_load_dwordx4 v10, s[24:27], s52 offen lds
  s_mov_b32 s52, 17752064
  s_add_u32 m0, s47, 57344
  s_nop 0
  buffer_load_dwordx4 v10, s[24:27], s52 offen lds
  s_mov_b32 s52, 17821696
  s_add_u32 m0, s47, 61440
  s_nop 0
  buffer_load_dwordx4 v10, s[24:27], s52 offen lds
  s_mov_b32 s52, 17891328
  s_add_u32 m0, s47, 65536
  s_nop 0
  buffer_load_dwordx4 v10, s[24:27], s52 offen lds
  s_mov_b32 s52, 17960960
  s_add_u32 m0, s47, 69632
  s_nop 0
  buffer_load_dwordx4 v10, s[24:27], s52 offen lds
  s_mov_b32 s52, 18030592
  s_add_u32 m0, s47, 73728
  s_nop 0
  buffer_load_dwordx4 v10, s[24:27], s52 offen lds
  s_mov_b32 s52, 18100224
  s_add_u32 m0, s47, 77824
  s_nop 0
  buffer_load_dwordx4 v10, s[24:27], s52 offen lds
  s_mov_b32 s52, 18169856
  s_add_u32 m0, s47, 81920
  s_nop 0
  buffer_load_dwordx4 v10, s[24:27], s52 offen lds
  s_mov_b32 s52, 18239488
  s_add_u32 m0, s47, 86016
  s_nop 0
  buffer_load_dwordx4 v10, s[24:27], s52 offen lds
  s_mov_b32 s52, 18309120
  s_add_u32 m0, s47, 90112
  s_nop 0
  buffer_load_dwordx4 v10, s[24:27], s52 offen lds
  s_mov_b32 s52, 18378752
  s_add_u32 m0, s47, 94208
  s_nop 0
  buffer_load_dwordx4 v10, s[24:27], s52 offen lds
  s_waitcnt vmcnt(20) lgkmcnt(0)
  s_barrier
  v_add_u32 v16, 0, v14
  v_add_u32 v18, 0, v15
  v_add_u32 v17, 98304, v13
  ds_read_b128 v[64:67], v17 offset:0
  ds_read_b64_tr_b16 v[68:69], v16 offset:0
  ds_read_b64_tr_b16 v[70:71], v16 offset:1024
  ds_read_b64_tr_b16 v[72:73], v18 offset:0
  ds_read_b64_tr_b16 v[74:75], v18 offset:1024
  ds_read_b128 v[76:79], v17 offset:1024
  ds_read_b64_tr_b16 v[80:81], v16 offset:4096
  ds_read_b64_tr_b16 v[82:83], v16 offset:5120
  ds_read_b64_tr_b16 v[84:85], v18 offset:4096
  ds_read_b64_tr_b16 v[86:87], v18 offset:5120
  ds_read_b128 v[88:91], v17 offset:2048
  ds_read_b64_tr_b16 v[92:93], v16 offset:8192
  ds_read_b64_tr_b16 v[94:95], v16 offset:9216
  ds_read_b64_tr_b16 v[96:97], v18 offset:8192
  ds_read_b64_tr_b16 v[98:99], v18 offset:9216
  ds_read_b128 v[100:103], v17 offset:3072
  ds_read_b64_tr_b16 v[104:105], v16 offset:12288
  ds_read_b64_tr_b16 v[106:107], v16 offset:13312
  ds_read_b64_tr_b16 v[108:109], v18 offset:12288
  ds_read_b64_tr_b16 v[110:111], v18 offset:13312
  s_waitcnt vmcnt(16) lgkmcnt(0)
  s_barrier
  v_add_u32 v16, 16384, v14
  v_add_u32 v18, 16384, v15
  v_add_u32 v17, 106496, v13
  ds_read_b128 v[112:115], v17 offset:0
  ds_read_b64_tr_b16 v[116:117], v16 offset:0
  ds_read_b64_tr_b16 v[118:119], v16 offset:1024
  ds_read_b64_tr_b16 v[120:121], v18 offset:0
  ds_read_b64_tr_b16 v[122:123], v18 offset:1024
  v_mfma_f32_32x32x16_bf16 v[32:47], v[64:67], v[68:71], 0
  v_mfma_f32_32x32x16_bf16 v[48:63], v[64:67], v[72:75], 0
  s_mov_b32 s52, 18448384
  s_add_u32 m0, s47, 0
  s_nop 0
  buffer_load_dwordx4 v10, s[24:27], s52 offen lds
  ds_read_b128 v[124:127], v17 offset:1024
  ds_read_b64_tr_b16 v[128:129], v16 offset:4096
  ds_read_b64_tr_b16 v[130:131], v16 offset:5120
  ds_read_b64_tr_b16 v[132:133], v18 offset:4096
  ds_read_b64_tr_b16 v[134:135], v18 offset:5120
  v_mfma_f32_32x32x16_bf16 v[32:47], v[76:79], v[80:83], v[32:47]
  v_mfma_f32_32x32x16_bf16 v[48:63], v[76:79], v[84:87], v[48:63]
  s_mov_b32 s52, 18518016
  s_add_u32 m0, s47, 4096
  s_nop 0
  buffer_load_dwordx4 v10, s[24:27], s52 offen lds
  ds_read_b128 v[136:139], v17 offset:2048
  ds_read_b64_tr_b16 v[140:141], v16 offset:8192
  ds_read_b64_tr_b16 v[142:143], v16 offset:9216
  ds_read_b64_tr_b16 v[144:145], v18 offset:8192
  ds_read_b64_tr_b16 v[146:147], v18 offset:9216
  v_mfma_f32_32x32x16_bf16 v[32:47], v[88:91], v[92:95], v[32:47]
  v_mfma_f32_32x32x16_bf16 v[48:63], v[88:91], v[96:99], v[48:63]
  s_mov_b32 s52, 18587648
  s_add_u32 m0, s47, 8192
  s_nop 0
  buffer_load_dwordx4 v10, s[24:27], s52 offen lds
  ds_read_b128 v[148:151], v17 offset:3072
  ds_read_b64_tr_b16 v[152:153], v16 offset:12288
  ds_read_b64_tr_b16 v[154:155], v16 offset:13312
  ds_read_b64_tr_b16 v[156:157], v18 offset:12288
  ds_read_b64_tr_b16 v[158:159], v18 offset:13312
  v_mfma_f32_32x32x16_bf16 v[32:47], v[100:103], v[104:107], v[32:47]
  v_mfma_f32_32x32x16_bf16 v[48:63], v[100:103], v[108:111], v[48:63]
  s_mov_b32 s52, 18657280
  s_add_u32 m0, s47, 12288
  s_nop 0
  buffer_load_dwordx4 v10, s[24:27], s52 offen lds
  s_waitcnt vmcnt(16) lgkmcnt(0)
  s_barrier
  v_add_u32 v16, 32768, v14
  v_add_u32 v18, 32768, v15
  v_add_u32 v17, 114688, v13
  ds_read_b128 v[64:67], v17 offset:0
  ds_read_b64_tr_b16 v[68:69], v16 offset:0
  ds_read_b64_tr_b16 v[70:71], v16 offset:1024
  ds_read_b64_tr_b16 v[72:73], v18 offset:0
  ds_read_b64_tr_b16 v[74:75], v18 offset:1024
  v_mfma_f32_32x32x16_bf16 v[32:47], v[112:115], v[116:119], v[32:47]
  v_mfma_f32_32x32x16_bf16 v[48:63], v[112:115], v[120:123], v[48:63]
  s_mov_b32 s52, 18726912
  s_add_u32 m0, s47, 16384
  s_nop 0
  buffer_load_dwordx4 v10, s[24:27], s52 offen lds
  ds_read_b128 v[76:79], v17 offset:1024
  ds_read_b64_tr_b16 v[80:81], v16 offset:4096
  ds_read_b64_tr_b16 v[82:83], v16 offset:5120
  ds_read_b64_tr_b16 v[84:85], v18 offset:4096
  ds_read_b64_tr_b16 v[86:87], v18 offset:5120
  v_mfma_f32_32x32x16_bf16 v[32:47], v[124:127], v[128:131], v[32:47]
  v_mfma_f32_32x32x16_bf16 v[48:63], v[124:127], v[132:135], v[48:63]
  s_mov_b32 s52, 18796544
  s_add_u32 m0, s47, 20480
  s_nop 0
  buffer_load_dwordx4 v10, s[24:27], s52 offen lds
  ds_read_b128 v[88:91], v17 offset:2048
  ds_read_b64_tr_b16 v[92:93], v16 offset:8192
  ds_read_b64_tr_b16 v[94:95], v16 offset:9216
  ds_read_b64_tr_b16 v[96:97], v18 offset:8192
  ds_read_b64_tr_b16 v[98:99], v18 offset:9216
  v_mfma_f32_32x32x16_bf16 v[32:47], v[136:139], v[140:143], v[32:47]
  v_mfma_f32_32x32x16_bf16 v[48:63], v[136:139], v[144:147], v[48:63]
  s_mov_b32 s52, 18866176
  s_add_u32 m0, s47, 24576
  s_nop 0
  buffer_load_dwordx4 v10, s[24:27], s52 offen lds
  ds_read_b128 v[100:103], v17 offset:3072
  ds_read_b64_tr_b16 v[104:105], v16 offset:12288
  ds_read_b64_tr_b16 v[106:107], v16 offset:13312
  ds_read_b64_tr_b16 v[108:109], v18 offset:12288
  ds_read_b64_tr_b16 v[110:111], v18 offset:13312
  v_mfma_f32_32x32x16_bf16 v[32:47], v[148:151], v[152:155], v[32:47]
  v_mfma_f32_32x32x16_bf16 v[48:63], v[148:151], v[156:159], v[48:63]
  s_mov_b32 s52, 18935808
  s_add_u32 m0, s47, 28672
  s_nop 0
  buffer_load_dwordx4 v10, s[24:27], s52 offen lds
  s_waitcnt vmcnt(16) lgkmcnt(0)
  s_barrier
  v_add_u32 v16, 49152, v14
  v_add_u32 v18, 49152, v15
  v_add_u32 v17, 122880, v13
  ds_read_b128 v[112:115], v17 offset:0
  ds_read_b64_tr_b16 v[116:117], v16 offset:0
  ds_read_b64_tr_b16 v[118:119], v16 offset:1024
  ds_read_b64_tr_b16 v[120:121], v18 offset:0
  ds_read_b64_tr_b16 v[122:123], v18 offset:1024
  v_mfma_f32_32x32x16_bf16 v[32:47], v[64:67], v[68:71], v[32:47]
  v_mfma_f32_32x32x16_bf16 v[48:63], v[64:67], v[72:75], v[48:63]
  ds_read_b128 v[124:127], v17 offset:1024
  ds_read_b64_tr_b16 v[128:129], v16 offset:4096
  ds_read_b64_tr_b16 v[130:131], v16 offset:5120
  ds_read_b64_tr_b16 v[132:133], v18 offset:4096
  ds_read_b64_tr_b16 v[134:135], v18 offset:5120
  v_mfma_f32_32x32x16_bf16 v[32:47], v[76:79], v[80:83], v[32:47]
  v_mfma_f32_32x32x16_bf16 v[48:63], v[76:79], v[84:87], v[48:63]
  ds_read_b128 v[136:139], v17 offset:2048
  ds_read_b64_tr_b16 v[140:141], v16 offset:8192
  ds_read_b64_tr_b16 v[142:143], v16 offset:9216
  ds_read_b64_tr_b16 v[144:145], v18 offset:8192
  ds_read_b64_tr_b16 v[146:147], v18 offset:9216
  v_mfma_f32_32x32x16_bf16 v[32:47], v[88:91], v[92:95], v[32:47]
  v_mfma_f32_32x32x16_bf16 v[48:63], v[88:91], v[96:99], v[48:63]
  ds_read_b128 v[148:151], v17 offset:3072
  ds_read_b64_tr_b16 v[152:153], v16 offset:12288
  ds_read_b64_tr_b16 v[154:155], v16 offset:13312
  ds_read_b64_tr_b16 v[156:157], v18 offset:12288
  ds_read_b64_tr_b16 v[158:159], v18 offset:13312
  v_mfma_f32_32x32x16_bf16 v[32:47], v[100:103], v[104:107], v[32:47]
  v_mfma_f32_32x32x16_bf16 v[48:63], v[100:103], v[108:111], v[48:63]
  s_waitcnt vmcnt(12) lgkmcnt(0)
  s_barrier
  v_add_u32 v16, 65536, v14
  v_add_u32 v18, 65536, v15
  v_add_u32 v17, 131072, v13
  ds_read_b128 v[64:67], v17 offset:0
  ds_read_b64_tr_b16 v[68:69], v16 offset:0
  ds_read_b64_tr_b16 v[70:71], v16 offset:1024
  ds_read_b64_tr_b16 v[72:73], v18 offset:0
  ds_read_b64_tr_b16 v[74:75], v18 offset:1024
  v_mfma_f32_32x32x16_bf16 v[32:47], v[112:115], v[116:119], v[32:47]
  v_mfma_f32_32x32x16_bf16 v[48:63], v[112:115], v[120:123], v[48:63]
  ds_read_b128 v[76:79], v17 offset:1024
  ds_read_b64_tr_b16 v[80:81], v16 offset:4096
  ds_read_b64_tr_b16 v[82:83], v16 offset:5120
  ds_read_b64_tr_b16 v[84:85], v18 offset:4096
  ds_read_b64_tr_b16 v[86:87], v18 offset:5120
  v_mfma_f32_32x32x16_bf16 v[32:47], v[124:127], v[128:131], v[32:47]
  v_mfma_f32_32x32x16_bf16 v[48:63], v[124:127], v[132:135], v[48:63]
  ds_read_b128 v[88:91], v17 offset:2048
  ds_read_b64_tr_b16 v[92:93], v16 offset:8192
  ds_read_b64_tr_b16 v[94:95], v16 offset:9216
  ds_read_b64_tr_b16 v[96:97], v18 offset:8192
  ds_read_b64_tr_b16 v[98:99], v18 offset:9216
  v_mfma_f32_32x32x16_bf16 v[32:47], v[136:139], v[140:143], v[32:47]
  v_mfma_f32_32x32x16_bf16 v[48:63], v[136:139], v[144:147], v[48:63]
  ds_read_b128 v[100:103], v17 offset:3072
  ds_read_b64_tr_b16 v[104:105], v16 offset:12288
  ds_read_b64_tr_b16 v[106:107], v16 offset:13312
  ds_read_b64_tr_b16 v[108:109], v18 offset:12288
  ds_read_b64_tr_b16 v[110:111], v18 offset:13312
  v_mfma_f32_32x32x16_bf16 v[32:47], v[148:151], v[152:155], v[32:47]
  v_mfma_f32_32x32x16_bf16 v[48:63], v[148:151], v[156:159], v[48:63]
  s_waitcnt vmcnt(8) lgkmcnt(0)
  s_barrier
  v_add_u32 v16, 81920, v14
  v_add_u32 v18, 81920, v15
  v_add_u32 v17, 139264, v13
  ds_read_b128 v[112:115], v17 offset:0
  ds_read_b64_tr_b16 v[116:117], v16 offset:0
  ds_read_b64_tr_b16 v[118:119], v16 offset:1024
  ds_read_b64_tr_b16 v[120:121], v18 offset:0
  ds_read_b64_tr_b16 v[122:123], v18 offset:1024
  v_mfma_f32_32x32x16_bf16 v[32:47], v[64:67], v[68:71], v[32:47]
  v_mfma_f32_32x32x16_bf16 v[48:63], v[64:67], v[72:75], v[48:63]
  ds_read_b128 v[124:127], v17 offset:1024
  ds_read_b64_tr_b16 v[128:129], v16 offset:4096
  ds_read_b64_tr_b16 v[130:131], v16 offset:5120
  ds_read_b64_tr_b16 v[132:133], v18 offset:4096
  ds_read_b64_tr_b16 v[134:135], v18 offset:5120
  v_mfma_f32_32x32x16_bf16 v[32:47], v[76:79], v[80:83], v[32:47]
  v_mfma_f32_32x32x16_bf16 v[48:63], v[76:79], v[84:87], v[48:63]
  ds_read_b128 v[136:139], v17 offset:2048
  ds_read_b64_tr_b16 v[140:141], v16 offset:8192
  ds_read_b64_tr_b16 v[142:143], v16 offset:9216
  ds_read_b64_tr_b16 v[144:145], v18 offset:8192
  ds_read_b64_tr_b16 v[146:147], v18 offset:9216
  v_mfma_f32_32x32x16_bf16 v[32:47], v[88:91], v[92:95], v[32:47]
  v_mfma_f32_32x32x16_bf16 v[48:63], v[88:91], v[96:99], v[48:63]
  ds_read_b128 v[148:151], v17 offset:3072
  ds_read_b64_tr_b16 v[152:153], v16 offset:12288
  ds_read_b64_tr_b16 v[154:155], v16 offset:13312
  ds_read_b64_tr_b16 v[156:157], v18 offset:12288
  ds_read_b64_tr_b16 v[158:159], v18 offset:13312
  v_mfma_f32_32x32x16_bf16 v[32:47], v[100:103], v[104:107], v[32:47]
  v_mfma_f32_32x32x16_bf16 v[48:63], v[100:103], v[108:111], v[48:63]
  s_waitcnt vmcnt(4) lgkmcnt(0)
  s_barrier
  v_add_u32 v16, 0, v14
  v_add_u32 v18, 0, v15
  v_add_u32 v17, 147456, v13
  ds_read_b128 v[64:67], v17 offset:0
  ds_read_b64_tr_b16 v[68:69], v16 offset:0
  ds_read_b64_tr_b16 v[70:71], v16 offset:1024
  ds_read_b64_tr_b16 v[72:73], v18 offset:0
  ds_read_b64_tr_b16 v[74:75], v18 offset:1024
  v_mfma_f32_32x32x16_bf16 v[32:47], v[112:115], v[116:119], v[32:47]
  v_mfma_f32_32x32x16_bf16 v[48:63], v[112:115], v[120:123], v[48:63]
  ds_read_b128 v[76:79], v17 offset:1024
  ds_read_b64_tr_b16 v[80:81], v16 offset:4096
  ds_read_b64_tr_b16 v[82:83], v16 offset:5120
  ds_read_b64_tr_b16 v[84:85], v18 offset:4096
  ds_read_b64_tr_b16 v[86:87], v18 offset:5120
  v_mfma_f32_32x32x16_bf16 v[32:47], v[124:127], v[128:131], v[32:47]
  v_mfma_f32_32x32x16_bf16 v[48:63], v[124:127], v[132:135], v[48:63]
  ds_read_b128 v[88:91], v17 offset:2048
  ds_read_b64_tr_b16 v[92:93], v16 offset:8192
  ds_read_b64_tr_b16 v[94:95], v16 offset:9216
  ds_read_b64_tr_b16 v[96:97], v18 offset:8192
  ds_read_b64_tr_b16 v[98:99], v18 offset:9216
  v_mfma_f32_32x32x16_bf16 v[32:47], v[136:139], v[140:143], v[32:47]
  v_mfma_f32_32x32x16_bf16 v[48:63], v[136:139], v[144:147], v[48:63]
  ds_read_b128 v[100:103], v17 offset:3072
  ds_read_b64_tr_b16 v[104:105], v16 offset:12288
  ds_read_b64_tr_b16 v[106:107], v16 offset:13312
  ds_read_b64_tr_b16 v[108:109], v18 offset:12288
  ds_read_b64_tr_b16 v[110:111], v18 offset:13312
  v_mfma_f32_32x32x16_bf16 v[32:47], v[148:151], v[152:155], v[32:47]
  v_mfma_f32_32x32x16_bf16 v[48:63], v[148:151], v[156:159], v[48:63]
  s_waitcnt vmcnt(0) lgkmcnt(0)
  s_barrier
  v_add_u32 v16, 16384, v14
  v_add_u32 v18, 16384, v15
  v_add_u32 v17, 155648, v13
  ds_read_b128 v[112:115], v17 offset:0
  ds_read_b64_tr_b16 v[116:117], v16 offset:0
  ds_read_b64_tr_b16 v[118:119], v16 offset:1024
  ds_read_b64_tr_b16 v[120:121], v18 offset:0
  ds_read_b64_tr_b16 v[122:123], v18 offset:1024
  v_mfma_f32_32x32x16_bf16 v[32:47], v[64:67], v[68:71], v[32:47]
  v_mfma_f32_32x32x16_bf16 v[48:63], v[64:67], v[72:75], v[48:63]
  ds_read_b128 v[124:127], v17 offset:1024
  ds_read_b64_tr_b16 v[128:129], v16 offset:4096
  ds_read_b64_tr_b16 v[130:131], v16 offset:5120
  ds_read_b64_tr_b16 v[132:133], v18 offset:4096
  ds_read_b64_tr_b16 v[134:135], v18 offset:5120
  v_mfma_f32_32x32x16_bf16 v[32:47], v[76:79], v[80:83], v[32:47]
  v_mfma_f32_32x32x16_bf16 v[48:63], v[76:79], v[84:87], v[48:63]
  ds_read_b128 v[136:139], v17 offset:2048
  ds_read_b64_tr_b16 v[140:141], v16 offset:8192
  ds_read_b64_tr_b16 v[142:143], v16 offset:9216
  ds_read_b64_tr_b16 v[144:145], v18 offset:8192
  ds_read_b64_tr_b16 v[146:147], v18 offset:9216
  v_mfma_f32_32x32x16_bf16 v[32:47], v[88:91], v[92:95], v[32:47]
  v_mfma_f32_32x32x16_bf16 v[48:63], v[88:91], v[96:99], v[48:63]
  ds_read_b128 v[148:151], v17 offset:3072
  ds_read_b64_tr_b16 v[152:153], v16 offset:12288
  ds_read_b64_tr_b16 v[154:155], v16 offset:13312
  ds_read_b64_tr_b16 v[156:157], v18 offset:12288
  ds_read_b64_tr_b16 v[158:159], v18 offset:13312
  v_mfma_f32_32x32x16_bf16 v[32:47], v[100:103], v[104:107], v[32:47]
  v_mfma_f32_32x32x16_bf16 v[48:63], v[100:103], v[108:111], v[48:63]
  s_waitcnt lgkmcnt(15)
  v_mfma_f32_32x32x16_bf16 v[32:47], v[112:115], v[116:119], v[32:47]
  v_mfma_f32_32x32x16_bf16 v[48:63], v[112:115], v[120:123], v[48:63]
  s_waitcnt lgkmcnt(10)
  v_mfma_f32_32x32x16_bf16 v[32:47], v[124:127], v[128:131], v[32:47]
  v_mfma_f32_32x32x16_bf16 v[48:63], v[124:127], v[132:135], v[48:63]
  s_waitcnt lgkmcnt(5)
  v_mfma_f32_32x32x16_bf16 v[32:47], v[136:139], v[140:143], v[32:47]
  v_mfma_f32_32x32x16_bf16 v[48:63], v[136:139], v[144:147], v[48:63]
  s_waitcnt lgkmcnt(0)
  v_mfma_f32_32x32x16_bf16 v[32:47], v[148:151], v[152:155], v[32:47]
  v_mfma_f32_32x32x16_bf16 v[48:63], v[148:151], v[156:159], v[48:63]
.Lk3_epi:
  v_and_b32 v2, 31, v0
  v_lshrrev_b32 v3, 5, v0
  v_mul_u32_u24 v2, 144, v2
  v_lshl_add_u32 v2, v3, 5, v2
  s_mul_i32 s50, s42, 9216
  s_lshl_b32 s51, s43, 6
  s_add_u32 s50, s50, s51
  s_add_u32 s50, s50, 32768
  v_add_u32 v2, s50, v2
  v_lshrrev_b32 v3, 3, v0
  v_and_b32 v4, 7, v0
  v_lshlrev_b32 v4, 4, v4
  v_mul_u32_u24 v5, 144, v3
  s_mul_i32 s50, s3, 4608
  s_add_u32 s50, s50, 32768
  v_add3_u32 v5, v5, v4, s50
  v_lshl_add_u32 v3, v3, 11, v4
  s_lshl_b32 s50, s45, 18
  s_lshl_b32 s51, s3, 16
  s_add_u32 s50, s50, s51
  s_lshl_b32 s51, s44, 7
  s_add_u32 s50, s50, s51
  s_add_u32 s50, s50, s49
  v_cvt_pk_bf16_f32 v80, v32, v33
  v_cvt_pk_bf16_f32 v81, v34, v35
  v_cvt_pk_bf16_f32 v82, v36, v37
  v_cvt_pk_bf16_f32 v83, v38, v39
  v_cvt_pk_bf16_f32 v84, v40, v41
  v_cvt_pk_bf16_f32 v85, v42, v43
  v_cvt_pk_bf16_f32 v86, v44, v45
  v_cvt_pk_bf16_f32 v87, v46, v47
  ds_write_b128 v2, v[80:83] offset:0
  ds_write_b128 v2, v[84:87] offset:16
  v_cvt_pk_bf16_f32 v88, v48, v49
  v_cvt_pk_bf16_f32 v89, v50, v51
  v_cvt_pk_bf16_f32 v90, v52, v53
  v_cvt_pk_bf16_f32 v91, v54, v55
  v_cvt_pk_bf16_f32 v92, v56, v57
  v_cvt_pk_bf16_f32 v93, v58, v59
  v_cvt_pk_bf16_f32 v94, v60, v61
  v_cvt_pk_bf16_f32 v95, v62, v63
  ds_write_b128 v2, v[88:91] offset:4608
  ds_write_b128 v2, v[92:95] offset:4624
  s_waitcnt lgkmcnt(0)
  s_barrier
  ds_read_b128 v[96:99], v5 offset:0
  ds_read_b128 v[100:103], v5 offset:1152
  ds_read_b128 v[104:107], v5 offset:2304
  ds_read_b128 v[108:111], v5 offset:3456
  s_waitcnt lgkmcnt(3)
  buffer_store_dwordx4 v[96:99], v3, s[28:31], s50 offen
  s_add_u32 s50, s50, 16384
  s_waitcnt lgkmcnt(2)
  buffer_store_dwordx4 v[100:103], v3, s[28:31], s50 offen
  s_add_u32 s50, s50, 16384
  s_waitcnt lgkmcnt(1)
  buffer_store_dwordx4 v[104:107], v3, s[28:31], s50 offen
  s_add_u32 s50, s50, 16384
  s_waitcnt lgkmcnt(0)
  buffer_store_dwordx4 v[108:111], v3, s[28:31], s50 offen
  s_add_u32 s50, s50, 16384
.Lfin_k2_kernel:
.Lend_k2_kernel:
  s_endpgm
.section .rodata,"a"
.p2align 6
.amdhsa_kernel k1_kernel
  .amdhsa_next_free_vgpr 208
  .amdhsa_next_free_sgpr 102
  .amdhsa_accum_offset 208
  .amdhsa_group_segment_fixed_size 0
  .amdhsa_kernarg_size 88
  .amdhsa_user_sgpr_count 2
  .amdhsa_user_sgpr_kernarg_segment_ptr 1
  .amdhsa_system_sgpr_workgroup_id_x 1
.end_amdhsa_kernel
.p2align 6
.amdhsa_kernel k2_kernel
  .amdhsa_next_free_vgpr 160
  .amdhsa_next_free_sgpr 102
  .amdhsa_accum_offset 160
  .amdhsa_group_segment_fixed_size 0
  .amdhsa_kernarg_size 88
  .amdhsa_user_sgpr_count 2
  .amdhsa_user_sgpr_kernarg_segment_ptr 1
  .amdhsa_system_sgpr_workgroup_id_x 1
.end_amdhsa_kernel
```
